```python
import torch

def _softmax(x, axis=-1):
    return torch.softmax(x, dim=axis)
def _gelu(x):
    return torch.nn.functional.gelu(x, approximate="tanh")
def _silu(x):
    return torch.nn.functional.silu(x)
def _sigmoid(x):
    return torch.sigmoid(x)
def _layernorm(x, axis=-1, eps=1e-5):
    m = x.mean(dim=axis, keepdim=True)
    v = x.var(dim=axis, keepdim=True, unbiased=False)
    return (x - m) / torch.sqrt(v + eps)
def _scatter_add(tgt, idx, src, axis=0):
    return tgt.clone().index_add_(axis, idx, src)
def _segment_sum(src, seg, n):
    out = torch.zeros((n,) + src.shape[1:], dtype=src.dtype)
    return out.index_add_(0, seg, src)
def _pad(x, pw):
    flat = tuple(v for pair in reversed(pw) for v in pair)
    return torch.nn.functional.pad(x, flat)

kernel_name = 'interleave_layers__sliding_block_cached__mixer_channel_mlp__decode'

def setup_inputs():

    _w = (lambda a: (lambda t: t.to(torch.bfloat16) if t.is_floating_point() else t)(torch.as_tensor(a)))
    def _A_setup():
        B, Sq, D = 1, 1, 448
        Hq, Hkv, Sk, Dh = 16, 8, 65536, 256
        assert Hq % Hkv == 0, (Hq, Hkv)
        return {
            "x": _w((lambda *s: torch.randn(*s, dtype=torch.bfloat16) * 0.05)(B, Sq, D)),
            "k_cache": _w((lambda *s: torch.randn(*s, dtype=torch.bfloat16) * 3.2)(B, Hkv, Sk, Dh)),
            "v_cache": _w((lambda *s: torch.randn(*s, dtype=torch.bfloat16) * 3.2)(B, Hkv, Sk, Dh)),
            "wq": _w((lambda *s: torch.randn(*s, dtype=torch.bfloat16) * 3.2)(D, Hq * Dh) * (D ** -0.5)),
            "wo": _w((lambda *s: torch.randn(*s, dtype=torch.bfloat16) * 3.2)(Hq * Dh, D) * ((Hq * Dh) ** -0.5)),
        }
    _A_in = _A_setup()

    def _B_setup():
        B, S, D, F = 1, 1, 448, 1792
        return {
            "x": _w((lambda *s: torch.randn(*s, dtype=torch.bfloat16) * 0.05)(B, S, D)),
            "w1": _w((lambda *s: torch.randn(*s, dtype=torch.bfloat16) * 3.2)(D, F) * (D ** -0.5)),
            "b1": _w((lambda *s: torch.randn(*s, dtype=torch.bfloat16) * 3.2)(F)),
            "w2": _w((lambda *s: torch.randn(*s, dtype=torch.bfloat16) * 3.2)(F, D) * (F ** -0.5)),
            "b2": _w((lambda *s: torch.randn(*s, dtype=torch.bfloat16) * 3.2)(D)),
        }
    _B_in = _B_setup()

    return {
        "A_x": _A_in["x"],
        "A_k_cache": _A_in["k_cache"],
        "A_v_cache": _A_in["v_cache"],
        "A_wq": _A_in["wq"],
        "A_wo": _A_in["wo"],
        "B_x": _B_in["x"],
        "B_w1": _B_in["w1"],
        "B_b1": _B_in["b1"],
        "B_w2": _B_in["w2"],
        "B_b2": _B_in["b2"],
    }

def reference(A_x, A_k_cache, A_v_cache, A_wq, A_wo, B_x, B_w1, B_b1, B_w2, B_b2):
    def _A_ref(x, k_cache, v_cache, wq, wo):
        B, Sq, D = x.shape
        Hq, Dh = 16, 256
        Hkv, Sk = k_cache.shape[1], k_cache.shape[2]
        W = min(4096, max(256, Sk // 4))
        rep = Hq // Hkv
        q = (lambda x, *d: x.permute(*d))((x @ wq).reshape(B, Sq, Hq, Dh), 0, 2, 1, 3)
        k = (lambda x, n, axis: torch.repeat_interleave(x, n, dim=axis))(k_cache[:, :, Sk - W:, :], rep, axis=1)
        v = (lambda x, n, axis: torch.repeat_interleave(x, n, dim=axis))(v_cache[:, :, Sk - W:, :], rep, axis=1)
        scores = torch.einsum("bhqd,bhkd->bhqk", q, k) * (Dh ** -0.5)
        p = _softmax(scores, axis=-1)
        o = torch.einsum("bhqk,bhkd->bhqd", p, v)
        return (lambda x, *d: x.permute(*d))(o, 0, 2, 1, 3).reshape(B, Sq, Hq * Dh) @ wo

    def _B_ref(x, w1, b1, w2, b2):
        y = _layernorm(x, axis=-1)
        h = _gelu(torch.einsum("bsd,df->bsf", y, w1) + b1)
        return torch.einsum("bsf,fd->bsd", h, w2) + b2

    x = A_x
    x = x + _A_ref(_layernorm(x, axis=-1), A_k_cache, A_v_cache, A_wq, A_wo)
    x = x + _B_ref(_layernorm(x, axis=-1), B_w1, B_b1, B_w2, B_b2)
    x = x + _A_ref(_layernorm(x, axis=-1), A_k_cache, A_v_cache, A_wq, A_wo)
    x = x + _B_ref(_layernorm(x, axis=-1), B_w1, B_b1, B_w2, B_b2)
    return x
```

```asm
; @launch grid=(256,1,1) block=(320,1,1) lds=155648
.amdgcn_target "amdgcn-amd-amdhsa--gfx950"
.text
.globl interleave_layers__sliding_block_cached__mixer_channel_mlp__decode_kernel
.p2align 8
.type interleave_layers__sliding_block_cached__mixer_channel_mlp__decode_kernel,@function
interleave_layers__sliding_block_cached__mixer_channel_mlp__decode_kernel:
    s_cmp_ge_u32 s2, 256
    s_cbranch_scc1 L_end
    s_load_dwordx16 s[4:19], s[0:1], 0
    s_load_dwordx8 s[20:27], s[0:1], 64
    s_load_dwordx2 s[28:29], s[0:1], 96
    s_and_b32 s30, s2, 7
    s_lshr_b32 s31, s2, 3
    s_min_u32 s45, s31, 27
    v_lshrrev_b32 v1, 6, v0
    v_and_b32 v0, 63, v0
    s_nop 1
    v_readfirstlane_b32 s32, v1
    s_mov_b32 s33, 1
    s_mov_b32 s34, 0
    s_mov_b32 s76, 0
    s_mov_b32 s56, -1
    s_mov_b32 s57, 16777215
    s_mov_b32 s58, 15
    s_mov_b32 s59, 0
    s_mov_b32 s60, -1
    s_mov_b32 s61, 0
    s_mov_b32 s66, 196611
    s_mov_b32 s67, 196611
    s_mov_b32 s68, 255
    s_mov_b32 s69, 0
    s_mov_b32 s70, 65535
    s_mov_b32 s71, 0
    s_mov_b32 s62, 4294901760
    s_mov_b32 s63, 4294901760
    s_mov_b32 s64, 0
    s_mov_b32 s65, -1
    s_mov_b32 s72, 0x3fb8aa3b
    s_mov_b32 s37, 0x3db8aa3b
    s_waitcnt lgkmcnt(0)
    s_cmp_eq_u32 s32, 4
    s_cbranch_scc1 L_ctrl
    s_lshl_b32 s40, s30, 25
    s_add_u32 s40, s40, 31457280
    s_lshl_b32 s41, s31, 16
    s_add_u32 s40, s40, s41
    s_lshl_b32 s41, s32, 14
    s_add_u32 s41, s40, s41
    s_add_u32 s38, s6, s41
    s_addc_u32 s39, s7, 0
    s_lshl_b32 s41, s32, 7
    s_add_u32 s41, s40, s41
    s_add_u32 s42, s8, s41
    s_addc_u32 s43, s9, 0
    s_lshl_b32 s44, s32, 15
    s_lshl_b32 s40, s30, 4
    v_mov_b32 v10, s40
    v_mov_b32 v8, 0
    v_mov_b32 v9, 0
    s_or_b32 s40, s31, s32
    s_cmp_lg_u32 s40, 0
    s_cbranch_scc1 L_att_nolead
    s_memrealtime s[48:49]
    s_waitcnt lgkmcnt(0)
    s_and_b32 s50, s48, 0xfffffff0
    s_or_b32 s51, s49, 0x80000000
    v_mov_b32 v8, s50
    v_mov_b32 v9, s51
    s_mov_b64 exec, 1
    global_store_dwordx2 v10, v[8:9], s[26:27]
    s_mov_b64 exec, -1
L_att_nolead:
    v_lshrrev_b32 v1, 5, v0
    v_and_b32 v2, 31, v0
    v_xor_b32 v2, v2, v1
    v_lshlrev_b32 v2, 4, v2
    v_lshlrev_b32 v1, 9, v1
    v_or_b32 v2, v2, v1
    v_lshrrev_b32 v1, 3, v0
    v_and_b32 v4, 7, v0
    v_lshrrev_b32 v5, 1, v4
    v_lshrrev_b32 v6, 1, v1
    v_and_b32 v6, 1, v6
    v_xor_b32 v5, v5, v6
    v_lshlrev_b32 v5, 5, v5
    v_and_b32 v4, 1, v4
    v_lshlrev_b32 v4, 4, v4
    v_or_b32 v5, v5, v4
    v_lshlrev_b32 v1, 9, v1
    v_or_b32 v5, v5, v1
    v_xor_b32 v6, 64, v5
    v_mov_b32 v11, 155216
    s_mov_b32 s75, 0
    v_mov_b32 v13, 0
    v_mov_b32 v14, 2097152
    s_cmp_lg_u32 s32, 0
    s_cbranch_scc1 L_tch_1
    global_load_dword v15, v13, s[28:29]
    global_load_dword v15, v13, s[26:27]
L_tch_1:
    s_cmp_lg_u32 s32, 1
    s_cbranch_scc1 L_tch_2
    global_load_dword v15, v14, s[28:29]
    global_load_dword v15, v13, s[24:25]
L_tch_2:
    s_cmp_lg_u32 s32, 2
    s_cbranch_scc1 L_tch_3
    global_load_dword v15, v13, s[12:13]
    global_load_dword v15, v13, s[20:21]
L_tch_3:
    s_cmp_lg_u32 s32, 3
    s_cbranch_scc1 L_tch_4
    global_load_dword v15, v13, s[16:17]
    global_load_dword v15, v13, s[8:9]
L_tch_4:
    s_barrier
    s_add_u32 m0, s44, 0
    v_xor_b32 v3, 0, v2
    v_add_u32 v3, 0, v3
    global_load_lds_dwordx4 v3, s[38:39] offset:0 nt
    v_xor_b32 v3, 32, v2
    v_add_u32 v3, 0, v3
    global_load_lds_dwordx4 v3, s[38:39] offset:1024 nt
    v_xor_b32 v3, 64, v2
    v_add_u32 v3, 0, v3
    global_load_lds_dwordx4 v3, s[38:39] offset:2048 nt
    v_xor_b32 v3, 96, v2
    v_add_u32 v3, 0, v3
    global_load_lds_dwordx4 v3, s[38:39] offset:3072 nt
    s_add_u32 m0, s44, 4096
    v_xor_b32 v3, 128, v2
    v_add_u32 v3, 4096, v3
    global_load_lds_dwordx4 v3, s[38:39] offset:0 nt
    v_xor_b32 v3, 160, v2
    v_add_u32 v3, 4096, v3
    global_load_lds_dwordx4 v3, s[38:39] offset:1024 nt
    v_xor_b32 v3, 192, v2
    v_add_u32 v3, 4096, v3
    global_load_lds_dwordx4 v3, s[38:39] offset:2048 nt
    v_xor_b32 v3, 224, v2
    v_add_u32 v3, 4096, v3
    global_load_lds_dwordx4 v3, s[38:39] offset:3072 nt
    s_add_u32 m0, s44, 8192
    v_xor_b32 v3, 0, v2
    v_add_u32 v3, 8192, v3
    s_cmp_lg_u32 s75, 0
    s_cbranch_scc1 L_go_5
    ds_read_b32 v12, v11
    s_waitcnt lgkmcnt(0)
    v_readfirstlane_b32 s75, v12
    s_waitcnt vmcnt(7)
L_go_5:
    global_load_lds_dwordx4 v3, s[38:39] offset:0 nt
    v_xor_b32 v3, 32, v2
    v_add_u32 v3, 8192, v3
    s_cmp_lg_u32 s75, 0
    s_cbranch_scc1 L_go_6
    ds_read_b32 v12, v11
    s_waitcnt lgkmcnt(0)
    v_readfirstlane_b32 s75, v12
    s_waitcnt vmcnt(7)
L_go_6:
    global_load_lds_dwordx4 v3, s[38:39] offset:1024 nt
    v_xor_b32 v3, 64, v2
    v_add_u32 v3, 8192, v3
    s_cmp_lg_u32 s75, 0
    s_cbranch_scc1 L_go_7
    ds_read_b32 v12, v11
    s_waitcnt lgkmcnt(0)
    v_readfirstlane_b32 s75, v12
    s_waitcnt vmcnt(7)
L_go_7:
    global_load_lds_dwordx4 v3, s[38:39] offset:2048 nt
    v_xor_b32 v3, 96, v2
    v_add_u32 v3, 8192, v3
    s_cmp_lg_u32 s75, 0
    s_cbranch_scc1 L_go_8
    ds_read_b32 v12, v11
    s_waitcnt lgkmcnt(0)
    v_readfirstlane_b32 s75, v12
    s_waitcnt vmcnt(7)
L_go_8:
    global_load_lds_dwordx4 v3, s[38:39] offset:3072 nt
    s_add_u32 m0, s44, 12288
    v_xor_b32 v3, 128, v2
    v_add_u32 v3, 12288, v3
    s_cmp_lg_u32 s75, 0
    s_cbranch_scc1 L_go_9
    ds_read_b32 v12, v11
    s_waitcnt lgkmcnt(0)
    v_readfirstlane_b32 s75, v12
    s_waitcnt vmcnt(7)
L_go_9:
    global_load_lds_dwordx4 v3, s[38:39] offset:0 nt
    v_xor_b32 v3, 160, v2
    v_add_u32 v3, 12288, v3
    s_cmp_lg_u32 s75, 0
    s_cbranch_scc1 L_go_10
    ds_read_b32 v12, v11
    s_waitcnt lgkmcnt(0)
    v_readfirstlane_b32 s75, v12
    s_waitcnt vmcnt(7)
L_go_10:
    global_load_lds_dwordx4 v3, s[38:39] offset:1024 nt
    v_xor_b32 v3, 192, v2
    v_add_u32 v3, 12288, v3
    s_cmp_lg_u32 s75, 0
    s_cbranch_scc1 L_go_11
    ds_read_b32 v12, v11
    s_waitcnt lgkmcnt(0)
    v_readfirstlane_b32 s75, v12
    s_waitcnt vmcnt(7)
L_go_11:
    global_load_lds_dwordx4 v3, s[38:39] offset:2048 nt
    v_xor_b32 v3, 224, v2
    v_add_u32 v3, 12288, v3
    s_cmp_lg_u32 s75, 0
    s_cbranch_scc1 L_go_12
    ds_read_b32 v12, v11
    s_waitcnt lgkmcnt(0)
    v_readfirstlane_b32 s75, v12
    s_waitcnt vmcnt(7)
L_go_12:
    global_load_lds_dwordx4 v3, s[38:39] offset:3072 nt
    s_add_u32 m0, s44, 16384
    v_add_u32 v3, 0, v5
    s_cmp_lg_u32 s75, 0
    s_cbranch_scc1 L_go_13
    ds_read_b32 v12, v11
    s_waitcnt lgkmcnt(0)
    v_readfirstlane_b32 s75, v12
    s_waitcnt vmcnt(7)
L_go_13:
    global_load_lds_dwordx4 v3, s[42:43] nt
    s_add_u32 m0, s44, 17408
    v_add_u32 v3, 4096, v6
    s_cmp_lg_u32 s75, 0
    s_cbranch_scc1 L_go_14
    ds_read_b32 v12, v11
    s_waitcnt lgkmcnt(0)
    v_readfirstlane_b32 s75, v12
    s_waitcnt vmcnt(7)
L_go_14:
    global_load_lds_dwordx4 v3, s[42:43] nt
    s_add_u32 m0, s44, 18432
    v_add_u32 v3, 8192, v5
    s_cmp_lg_u32 s75, 0
    s_cbranch_scc1 L_go_15
    ds_read_b32 v12, v11
    s_waitcnt lgkmcnt(0)
    v_readfirstlane_b32 s75, v12
    s_waitcnt vmcnt(7)
L_go_15:
    global_load_lds_dwordx4 v3, s[42:43] nt
    s_add_u32 m0, s44, 19456
    v_add_u32 v3, 12288, v6
    s_cmp_lg_u32 s75, 0
    s_cbranch_scc1 L_go_16
    ds_read_b32 v12, v11
    s_waitcnt lgkmcnt(0)
    v_readfirstlane_b32 s75, v12
    s_waitcnt vmcnt(7)
L_go_16:
    global_load_lds_dwordx4 v3, s[42:43] nt
    s_add_u32 m0, s44, 20480
    v_add_u32 v3, 16384, v5
    s_cmp_lg_u32 s75, 0
    s_cbranch_scc1 L_go_17
    ds_read_b32 v12, v11
    s_waitcnt lgkmcnt(0)
    v_readfirstlane_b32 s75, v12
    s_waitcnt vmcnt(7)
L_go_17:
    global_load_lds_dwordx4 v3, s[42:43] nt
    s_add_u32 m0, s44, 21504
    v_add_u32 v3, 20480, v6
    s_cmp_lg_u32 s75, 0
    s_cbranch_scc1 L_go_18
    ds_read_b32 v12, v11
    s_waitcnt lgkmcnt(0)
    v_readfirstlane_b32 s75, v12
    s_waitcnt vmcnt(7)
L_go_18:
    global_load_lds_dwordx4 v3, s[42:43] nt
    s_add_u32 m0, s44, 22528
    v_add_u32 v3, 24576, v5
    s_cmp_lg_u32 s75, 0
    s_cbranch_scc1 L_go_19
    ds_read_b32 v12, v11
    s_waitcnt lgkmcnt(0)
    v_readfirstlane_b32 s75, v12
    s_waitcnt vmcnt(7)
L_go_19:
    global_load_lds_dwordx4 v3, s[42:43] nt
    s_add_u32 m0, s44, 23552
    v_add_u32 v3, 28672, v6
    s_cmp_lg_u32 s75, 0
    s_cbranch_scc1 L_go_20
    ds_read_b32 v12, v11
    s_waitcnt lgkmcnt(0)
    v_readfirstlane_b32 s75, v12
    s_waitcnt vmcnt(7)
L_go_20:
    global_load_lds_dwordx4 v3, s[42:43] nt
    s_add_u32 m0, s44, 24576
    v_add_u32 v3, 32768, v5
    s_cmp_lg_u32 s75, 0
    s_cbranch_scc1 L_go_21
    ds_read_b32 v12, v11
    s_waitcnt lgkmcnt(0)
    v_readfirstlane_b32 s75, v12
    s_waitcnt vmcnt(7)
L_go_21:
    global_load_lds_dwordx4 v3, s[42:43] nt
    s_add_u32 m0, s44, 25600
    v_add_u32 v3, 36864, v6
    s_cmp_lg_u32 s75, 0
    s_cbranch_scc1 L_go_22
    ds_read_b32 v12, v11
    s_waitcnt lgkmcnt(0)
    v_readfirstlane_b32 s75, v12
    s_waitcnt vmcnt(7)
L_go_22:
    global_load_lds_dwordx4 v3, s[42:43] nt
    s_add_u32 m0, s44, 26624
    v_add_u32 v3, 40960, v5
    s_cmp_lg_u32 s75, 0
    s_cbranch_scc1 L_go_23
    ds_read_b32 v12, v11
    s_waitcnt lgkmcnt(0)
    v_readfirstlane_b32 s75, v12
    s_waitcnt vmcnt(7)
L_go_23:
    global_load_lds_dwordx4 v3, s[42:43] nt
    s_add_u32 m0, s44, 27648
    v_add_u32 v3, 45056, v6
    s_cmp_lg_u32 s75, 0
    s_cbranch_scc1 L_go_24
    ds_read_b32 v12, v11
    s_waitcnt lgkmcnt(0)
    v_readfirstlane_b32 s75, v12
    s_waitcnt vmcnt(7)
L_go_24:
    global_load_lds_dwordx4 v3, s[42:43] nt
    s_add_u32 m0, s44, 28672
    v_add_u32 v3, 49152, v5
    s_cmp_lg_u32 s75, 0
    s_cbranch_scc1 L_go_25
    ds_read_b32 v12, v11
    s_waitcnt lgkmcnt(0)
    v_readfirstlane_b32 s75, v12
    s_waitcnt vmcnt(7)
L_go_25:
    global_load_lds_dwordx4 v3, s[42:43] nt
    s_add_u32 m0, s44, 29696
    v_add_u32 v3, 53248, v6
    s_cmp_lg_u32 s75, 0
    s_cbranch_scc1 L_go_26
    ds_read_b32 v12, v11
    s_waitcnt lgkmcnt(0)
    v_readfirstlane_b32 s75, v12
    s_waitcnt vmcnt(7)
L_go_26:
    global_load_lds_dwordx4 v3, s[42:43] nt
    s_add_u32 m0, s44, 30720
    v_add_u32 v3, 57344, v5
    s_cmp_lg_u32 s75, 0
    s_cbranch_scc1 L_go_27
    ds_read_b32 v12, v11
    s_waitcnt lgkmcnt(0)
    v_readfirstlane_b32 s75, v12
    s_waitcnt vmcnt(7)
L_go_27:
    global_load_lds_dwordx4 v3, s[42:43] nt
    s_add_u32 m0, s44, 31744
    v_add_u32 v3, 61440, v6
    s_cmp_lg_u32 s75, 0
    s_cbranch_scc1 L_go_28
    ds_read_b32 v12, v11
    s_waitcnt lgkmcnt(0)
    v_readfirstlane_b32 s75, v12
    s_waitcnt vmcnt(7)
L_go_28:
    global_load_lds_dwordx4 v3, s[42:43] nt
    v_and_b32 v1, 15, v0
    v_lshrrev_b32 v2, 4, v0
    v_xor_b32 v3, v2, v1
    v_lshlrev_b32 v3, 4, v3
    v_lshlrev_b32 v4, 9, v1
    v_or_b32 v3, v3, v4
    v_add_u32 v3, s44, v3
    v_mov_b32 v216, v3
    v_lshrrev_b32 v3, 2, v1
    v_and_b32 v4, 3, v0
    v_lshrrev_b32 v5, 1, v3
    v_and_b32 v5, 1, v5
    v_and_b32 v6, 1, v2
    v_lshlrev_b32 v6, 1, v6
    v_or_b32 v5, v5, v6
    v_lshlrev_b32 v6, 3, v2
    v_add_u32 v6, v6, v3
    v_lshlrev_b32 v6, 7, v6
    v_lshlrev_b32 v4, 3, v4
    v_add_u32 v6, v6, v4
    v_add_u32 v6, s44, v6
    v_add_u32 v6, 16384, v6
    v_xor_b32 v7, 0, v5
    v_lshlrev_b32 v7, 5, v7
    v_add_u32 v224, v6, v7
    v_xor_b32 v7, 1, v5
    v_lshlrev_b32 v7, 5, v7
    v_add_u32 v225, v6, v7
    v_xor_b32 v7, 2, v5
    v_lshlrev_b32 v7, 5, v7
    v_add_u32 v226, v6, v7
    v_xor_b32 v7, 3, v5
    v_lshlrev_b32 v7, 5, v7
    v_add_u32 v227, v6, v7
    v_and_b32 v3, 1, v0
    v_lshlrev_b32 v4, 4, v2
    v_lshlrev_b32 v5, 9, v3
    v_add_u32 v5, v5, v4
    v_add_u32 v228, 153600, v5
    v_lshlrev_b32 v5, 8, v3
    v_add_u32 v5, v5, v4
    v_add_u32 v229, 154624, v5
    v_lshlrev_b32 v5, 2, v3
    v_add_u32 v233, 155136, v5
    v_and_b32 v4, 1, v2
    v_lshlrev_b32 v5, 8, v4
    v_lshrrev_b32 v6, 1, v2
    v_lshlrev_b32 v6, 4, v6
    v_add_u32 v6, v6, v1
    s_lshl_b32 s40, s32, 5
    v_add_u32 v6, s40, v6
    v_lshlrev_b32 v6, 1, v6
    v_add_u32 v5, v5, v6
    v_add_u32 v230, 154624, v5
    v_lshlrev_b32 v5, 2, v4
    v_add_u32 v232, 155136, v5
    s_lshl_b32 s40, s32, 3
    v_add_u32 v231, s40, v232
    s_lshl_b32 s40, s30, 5
    s_lshl_b32 s41, s32, 2
    s_add_u32 s40, s40, s41
    s_lshl_b32 s40, s40, 12
    s_lshl_b32 s41, s31, 6
    s_add_u32 s40, s40, s41
    s_add_u32 s40, s40, 1048576
    v_lshlrev_b32 v5, 16, v3
    v_lshlrev_b32 v6, 4, v2
    v_add_u32 v5, v5, v6
    v_add_u32 v234, s40, v5
    s_lshl_b32 s40, s30, 5
    s_lshl_b32 s41, s32, 2
    s_add_u32 s40, s40, s41
    s_lshl_b32 s40, s40, 12
    s_lshl_b32 s41, s31, 3
    s_add_u32 s40, s40, s41
    s_add_u32 s40, s40, 1050624
    v_lshlrev_b32 v5, 16, v3
    v_lshrrev_b32 v6, 1, v0
    v_and_b32 v6, 3, v6
    v_lshlrev_b32 v6, 12, v6
    v_add_u32 v5, v5, v6
    v_add_u32 v235, s40, v5
    s_waitcnt vmcnt(16)
    v_xor_b32 v3, 0, v216
    ds_read_b128 v[16:19], v3 offset:0
    ds_read_b128 v[48:51], v3 offset:8192
    v_xor_b32 v3, 64, v216
    ds_read_b128 v[20:23], v3 offset:0
    ds_read_b128 v[52:55], v3 offset:8192
    v_xor_b32 v3, 128, v216
    ds_read_b128 v[24:27], v3 offset:0
    ds_read_b128 v[56:59], v3 offset:8192
    v_xor_b32 v3, 192, v216
    ds_read_b128 v[28:31], v3 offset:0
    ds_read_b128 v[60:63], v3 offset:8192
    v_xor_b32 v3, 256, v216
    ds_read_b128 v[32:35], v3 offset:0
    ds_read_b128 v[64:67], v3 offset:8192
    v_xor_b32 v3, 320, v216
    ds_read_b128 v[36:39], v3 offset:0
    ds_read_b128 v[68:71], v3 offset:8192
    v_xor_b32 v3, 384, v216
    ds_read_b128 v[40:43], v3 offset:0
    ds_read_b128 v[72:75], v3 offset:8192
    v_xor_b32 v3, 448, v216
    ds_read_b128 v[44:47], v3 offset:0
    ds_read_b128 v[76:79], v3 offset:8192
    s_waitcnt lgkmcnt(0)
    v_lshlrev_b32 v1, 4, v0
    s_lshl_b32 s40, s30, 5
    s_add_u32 s40, s40, s31
    s_mul_i32 s40, s40, 14336
    s_mul_i32 s41, s32, 896
    s_add_u32 s40, s40, s41
    v_add_u32 v2, s40, v1
    s_mul_i32 s40, s30, 28
    s_add_u32 s40, s40, s45
    s_mul_i32 s73, s40, 7168
    s_add_u32 s73, s73, s41
    v_add_u32 v4, s73, v1
    s_mov_b64 exec, s[56:57]
    s_add_u32 m0, s44, 0
    v_add_u32 v3, 0, v2
    global_load_lds_dwordx4 v3, s[12:13] nt
    s_add_u32 m0, s44, 1024
    v_add_u32 v3, 3584, v2
    global_load_lds_dwordx4 v3, s[12:13] nt
    s_add_u32 m0, s44, 2048
    v_add_u32 v3, 7168, v2
    global_load_lds_dwordx4 v3, s[12:13] nt
    s_add_u32 m0, s44, 3072
    v_add_u32 v3, 10752, v2
    global_load_lds_dwordx4 v3, s[12:13] nt
    s_add_u32 m0, s44, 4096
    v_add_u32 v3, 0, v4
    global_load_lds_dwordx4 v3, s[20:21] nt
    s_add_u32 m0, s44, 5120
    v_add_u32 v3, 3584, v4
    global_load_lds_dwordx4 v3, s[20:21] nt
    s_mov_b64 exec, -1
    s_lshl_b32 s41, s40, 4
    s_mov_b32 s73, 3584
    v_mul_lo_u32 v2, s73, v0
    s_mul_i32 s73, s32, 229376
    s_add_u32 s41, s41, s73
    v_add_u32 v2, s41, v2
    s_lshl_b32 s40, s32, 10
    s_add_u32 m0, s40, 145408
    s_nop 0
    global_load_lds_dwordx4 v2, s[16:17]
    s_cmp_eq_u32 s32, 3
    s_cbranch_scc1 L_att_now1
    s_add_u32 m0, s40, 149504
    v_add_u32 v2, 917504, v2
    global_load_lds_dwordx4 v2, s[16:17]
L_att_now1:
    s_cmp_lg_u32 s32, 0
    s_cbranch_scc1 L_att_nox
    s_cmp_lg_u32 s31, 0
    s_cbranch_scc1 L_att_nolead2
    s_mov_b64 exec, 1
    global_store_dwordx2 v10, v[8:9], s[26:27] offset:128 sc1
    s_mov_b64 exec, -1
L_att_nolead2:
    v_mov_b32 v12, 0
    v_mov_b32 v13, 0
    v_mov_b32 v14, 0
    v_mov_b32 v15, 0
    s_lshl_b32 s40, s31, 9
    s_lshl_b32 s41, s30, 6
    s_add_u32 s40, s40, s41
    s_add_u32 s40, s40, 196608
    v_lshlrev_b32 v11, 4, v0
    v_add_u32 v11, s40, v11
    v_add_u32 v7, 65536, v11
    s_mov_b64 exec, s[58:59]
    global_store_dwordx4 v11, v[12:15], s[28:29] sc1
    global_store_dwordx4 v7, v[12:15], s[28:29] sc1
    s_mov_b64 exec, -1
L_att_nox:
L_att_layer:
    s_barrier
    ds_read_b128 v[144:147], v228 offset:0
    ds_read_b128 v[148:151], v228 offset:64
    ds_read_b128 v[152:155], v228 offset:128
    ds_read_b128 v[156:159], v228 offset:192
    ds_read_b128 v[160:163], v228 offset:256
    ds_read_b128 v[164:167], v228 offset:320
    ds_read_b128 v[168:171], v228 offset:384
    ds_read_b128 v[172:175], v228 offset:448
    s_waitcnt lgkmcnt(6)
    v_mfma_f32_16x16x32_bf16 v[176:179], v[144:147], v[16:19], 0
    v_mfma_f32_16x16x32_bf16 v[180:183], v[144:147], v[48:51], 0
    v_mfma_f32_16x16x32_bf16 v[176:179], v[148:151], v[20:23], v[176:179]
    v_mfma_f32_16x16x32_bf16 v[180:183], v[148:151], v[52:55], v[180:183]
    s_waitcnt lgkmcnt(4)
    v_mfma_f32_16x16x32_bf16 v[176:179], v[152:155], v[24:27], v[176:179]
    v_mfma_f32_16x16x32_bf16 v[180:183], v[152:155], v[56:59], v[180:183]
    v_mfma_f32_16x16x32_bf16 v[176:179], v[156:159], v[28:31], v[176:179]
    v_mfma_f32_16x16x32_bf16 v[180:183], v[156:159], v[60:63], v[180:183]
    s_waitcnt lgkmcnt(2)
    v_mfma_f32_16x16x32_bf16 v[176:179], v[160:163], v[32:35], v[176:179]
    v_mfma_f32_16x16x32_bf16 v[180:183], v[160:163], v[64:67], v[180:183]
    v_mfma_f32_16x16x32_bf16 v[176:179], v[164:167], v[36:39], v[176:179]
    v_mfma_f32_16x16x32_bf16 v[180:183], v[164:167], v[68:71], v[180:183]
    s_waitcnt lgkmcnt(0)
    v_mfma_f32_16x16x32_bf16 v[176:179], v[168:171], v[40:43], v[176:179]
    v_mfma_f32_16x16x32_bf16 v[180:183], v[168:171], v[72:75], v[180:183]
    v_mfma_f32_16x16x32_bf16 v[176:179], v[172:175], v[44:47], v[176:179]
    v_mfma_f32_16x16x32_bf16 v[180:183], v[172:175], v[76:79], v[180:183]
    s_nop 8
    v_cndmask_b32 v236, v176, v177, s[62:63]
    v_cndmask_b32 v237, v180, v181, s[62:63]
    v_cndmask_b32 v236, v236, v237, s[64:65]
    v_cvt_pk_bf16_f32 v236, v236, v236
    v_lshlrev_b32 v236, 16, v236
    v_mul_f32 v236, 0x3d800000, v236
    v_mov_b32 v237, v236
    s_nop 1
    v_max_f32_dpp v237, v237, v237 row_ror:8 row_mask:0xf bank_mask:0xf
    s_nop 1
    v_max_f32_dpp v237, v237, v237 row_ror:4 row_mask:0xf bank_mask:0xf
    s_nop 1
    v_max_f32_dpp v237, v237, v237 row_ror:2 row_mask:0xf bank_mask:0xf
    s_nop 1
    v_max_f32_dpp v237, v237, v237 row_ror:1 row_mask:0xf bank_mask:0xf
    s_nop 1
    v_mov_b32 v238, v237
    s_nop 1
    v_permlane32_swap_b32 v237, v238
    s_nop 0
    v_max_f32 v237, v237, v238
    ds_write_b32 v231, v237
    s_waitcnt lgkmcnt(0)
    s_barrier
    ds_read2_b32 v[238:239], v232 offset0:0 offset1:2
    ds_read2_b32 v[240:241], v232 offset0:4 offset1:6
    s_waitcnt lgkmcnt(0)
    v_max_f32 v238, v238, v239
    v_max3_f32 v238, v238, v240, v241
    v_sub_f32 v236, v236, v238
    v_mul_f32 v236, s72, v236
    v_exp_f32 v236, v236
    s_nop 0
    v_cvt_pk_bf16_f32 v237, v236, v236
    ds_write_b16 v230, v237
    s_nop 1
    v_add_f32_dpp v236, v236, v236 row_ror:8 row_mask:0xf bank_mask:0xf
    s_nop 1
    v_add_f32_dpp v236, v236, v236 row_ror:4 row_mask:0xf bank_mask:0xf
    s_nop 1
    v_add_f32_dpp v236, v236, v236 row_ror:2 row_mask:0xf bank_mask:0xf
    s_nop 1
    v_add_f32_dpp v236, v236, v236 row_ror:1 row_mask:0xf bank_mask:0xf
    s_nop 1
    v_mov_b32 v238, v236
    s_nop 1
    v_permlane32_swap_b32 v236, v238
    s_nop 0
    v_add_f32 v236, v236, v238
    ds_write_b32 v231, v236 offset:32
    s_cmp_lg_u32 s76, 0
    s_cbranch_scc1 L_att_skipv
    s_cmp_eq_u32 s32, 0
    s_cbranch_scc1 L_att_vw0
    s_cmp_eq_u32 s32, 3
    s_cbranch_scc1 L_att_vw3
    s_waitcnt vmcnt(8)
    s_branch L_att_vwd
L_att_vw3:
    s_waitcnt vmcnt(7)
    s_branch L_att_vwd
L_att_vw0:
    s_waitcnt vmcnt(10)
L_att_vwd:
    ds_read_b64_tr_b16 v[80:81], v224 offset:0
    ds_read_b64_tr_b16 v[82:83], v224 offset:512
    ds_read_b64_tr_b16 v[84:85], v224 offset:4096
    ds_read_b64_tr_b16 v[86:87], v224 offset:4608
    ds_read_b64_tr_b16 v[88:89], v224 offset:8192
    ds_read_b64_tr_b16 v[90:91], v224 offset:8704
    ds_read_b64_tr_b16 v[92:93], v224 offset:12288
    ds_read_b64_tr_b16 v[94:95], v224 offset:12800
    ds_read_b64_tr_b16 v[96:97], v225 offset:0
    ds_read_b64_tr_b16 v[98:99], v225 offset:512
    ds_read_b64_tr_b16 v[100:101], v225 offset:4096
    ds_read_b64_tr_b16 v[102:103], v225 offset:4608
    ds_read_b64_tr_b16 v[104:105], v225 offset:8192
    ds_read_b64_tr_b16 v[106:107], v225 offset:8704
    ds_read_b64_tr_b16 v[108:109], v225 offset:12288
    ds_read_b64_tr_b16 v[110:111], v225 offset:12800
    ds_read_b64_tr_b16 v[112:113], v226 offset:0
    ds_read_b64_tr_b16 v[114:115], v226 offset:512
    ds_read_b64_tr_b16 v[116:117], v226 offset:4096
    ds_read_b64_tr_b16 v[118:119], v226 offset:4608
    ds_read_b64_tr_b16 v[120:121], v226 offset:8192
    ds_read_b64_tr_b16 v[122:123], v226 offset:8704
    ds_read_b64_tr_b16 v[124:125], v226 offset:12288
    ds_read_b64_tr_b16 v[126:127], v226 offset:12800
    ds_read_b64_tr_b16 v[128:129], v227 offset:0
    ds_read_b64_tr_b16 v[130:131], v227 offset:512
    ds_read_b64_tr_b16 v[132:133], v227 offset:4096
    ds_read_b64_tr_b16 v[134:135], v227 offset:4608
    ds_read_b64_tr_b16 v[136:137], v227 offset:8192
    ds_read_b64_tr_b16 v[138:139], v227 offset:8704
    ds_read_b64_tr_b16 v[140:141], v227 offset:12288
    ds_read_b64_tr_b16 v[142:143], v227 offset:12800
L_att_skipv:
    s_waitcnt lgkmcnt(0)
    s_barrier
    ds_read_b128 v[184:187], v229 offset:0
    ds_read_b128 v[188:191], v229 offset:64
    ds_read_b128 v[192:195], v229 offset:128
    ds_read_b128 v[196:199], v229 offset:192
    ds_read2_b32 v[238:239], v233 offset0:0 offset1:2
    ds_read2_b32 v[240:241], v233 offset0:4 offset1:6
    ds_read2_b32 v[242:243], v233 offset0:8 offset1:10
    ds_read2_b32 v[244:245], v233 offset0:12 offset1:14
    v_mov_b32 v236, 155200
    ds_read_b32 v237, v236
    s_waitcnt lgkmcnt(8)
    v_mfma_f32_16x16x32_bf16 v[200:203], v[80:83], v[184:187], 0
    v_mfma_f32_16x16x32_bf16 v[204:207], v[96:99], v[184:187], 0
    v_mfma_f32_16x16x32_bf16 v[208:211], v[112:115], v[184:187], 0
    v_mfma_f32_16x16x32_bf16 v[212:215], v[128:131], v[184:187], 0
    s_waitcnt lgkmcnt(7)
    v_mfma_f32_16x16x32_bf16 v[200:203], v[84:87], v[188:191], v[200:203]
    v_mfma_f32_16x16x32_bf16 v[204:207], v[100:103], v[188:191], v[204:207]
    v_mfma_f32_16x16x32_bf16 v[208:211], v[116:119], v[188:191], v[208:211]
    v_mfma_f32_16x16x32_bf16 v[212:215], v[132:135], v[188:191], v[212:215]
    s_waitcnt lgkmcnt(6)
    v_mfma_f32_16x16x32_bf16 v[200:203], v[88:91], v[192:195], v[200:203]
    v_mfma_f32_16x16x32_bf16 v[204:207], v[104:107], v[192:195], v[204:207]
    v_mfma_f32_16x16x32_bf16 v[208:211], v[120:123], v[192:195], v[208:211]
    v_mfma_f32_16x16x32_bf16 v[212:215], v[136:139], v[192:195], v[212:215]
    s_waitcnt lgkmcnt(5)
    v_mfma_f32_16x16x32_bf16 v[200:203], v[92:95], v[196:199], v[200:203]
    v_mfma_f32_16x16x32_bf16 v[204:207], v[108:111], v[196:199], v[204:207]
    v_mfma_f32_16x16x32_bf16 v[208:211], v[124:127], v[196:199], v[208:211]
    v_mfma_f32_16x16x32_bf16 v[212:215], v[140:143], v[196:199], v[212:215]
    s_waitcnt lgkmcnt(0)
    v_readfirstlane_b32 s34, v237
    v_max_f32 v238, v238, v239
    v_max3_f32 v238, v238, v240, v241
    v_add_f32 v239, v242, v243
    v_add_f32 v240, v244, v245
    v_add_f32 v239, v239, v240
    v_bfi_b32 v238, 3, s33, v238
    v_add_u32 v240, 4096, v234
    v_add_u32 v241, 8192, v234
    v_add_u32 v242, 12288, v234
    s_mov_b64 exec, s[68:69]
    s_cmp_eq_u32 s34, 1
    s_cbranch_scc1 L_f_29
    global_store_dwordx2 v235, v[238:239], s[28:29] sc1
    s_branch L_e_30
L_f_29:
    global_store_dwordx2 v235, v[238:239], s[28:29]
L_e_30:
    s_mov_b64 exec, s[66:67]
    v_bfi_b32 v200, 3, s33, v200
    v_bfi_b32 v204, 3, s33, v204
    v_bfi_b32 v208, 3, s33, v208
    v_bfi_b32 v212, 3, s33, v212
    s_cmp_eq_u32 s34, 1
    s_cbranch_scc1 L_f_31
    global_store_dwordx4 v234, v[200:203], s[28:29] sc1
    global_store_dwordx4 v240, v[204:207], s[28:29] sc1
    global_store_dwordx4 v241, v[208:211], s[28:29] sc1
    global_store_dwordx4 v242, v[212:215], s[28:29] sc1
    s_branch L_e_32
L_f_31:
    global_store_dwordx4 v234, v[200:203], s[28:29]
    global_store_dwordx4 v240, v[204:207], s[28:29]
    global_store_dwordx4 v241, v[208:211], s[28:29]
    global_store_dwordx4 v242, v[212:215], s[28:29]
L_e_32:
    s_mov_b64 exec, -1
    s_cmp_lg_u32 s76, 0
    s_cbranch_scc1 L_att_noxr
    s_waitcnt vmcnt(0)
    s_barrier
    s_cmp_lg_u32 s32, 0
    s_cbranch_scc1 L_att_noxr
    v_mov_b32 v238, 155208
    ds_read_b64 v[240:241], v238
    s_lshl_b32 s40, s31, 6
    s_lshl_b32 s41, s30, 3
    s_add_u32 s40, s40, s41
    s_add_u32 s40, s40, 339968
    v_mov_b32 v238, s40
    s_waitcnt lgkmcnt(0)
    s_mov_b64 exec, 1
    global_store_dwordx2 v238, v[240:241], s[28:29] sc1
    s_mov_b64 exec, -1
L_att_noxr:
    s_add_u32 s76, s76, 1
    s_lshl_b32 s33, s33, 1
    s_cmp_lt_u32 s76, 2
    s_cbranch_scc1 L_att_layer
    s_endpgm
L_ctrl:
    v_mov_b32 v80, 0
    v_mov_b32 v81, 0
    v_mov_b32 v82, 0
    v_mov_b32 v83, 0
    v_mov_b32 v224, 0
    v_mov_b32 v72, 0
    v_mov_b32 v225, 0
    v_mov_b32 v73, 0
    v_mov_b32 v226, 0
    v_mov_b32 v74, 0
    v_mov_b32 v227, 0
    v_mov_b32 v75, 0
    v_mov_b32 v228, 0
    v_mov_b32 v76, 0
    v_mov_b32 v229, 0
    v_mov_b32 v77, 0
    v_mov_b32 v230, 0
    v_mov_b32 v78, 0
    v_mov_b32 v231, 0
    v_mov_b32 v79, 0
    v_lshlrev_b32 v5, 4, v0
    s_mov_b64 exec, s[56:57]
    global_load_dwordx4 v[72:75], v5, s[4:5]
    s_mov_b64 exec, -1
    v_and_b32 v14, 3, v0
    v_lshlrev_b32 v14, 3, v14
    s_lshl_b32 s40, s45, 5
    v_add_u32 v14, s40, v14
    global_load_dwordx2 v[240:241], v14, s[4:5]
    global_load_dwordx2 v[236:237], v14, s[22:23]
    s_mul_i32 s40, s30, 28
    s_add_u32 s40, s40, s45
    s_lshl_b32 s41, s40, 4
    v_and_b32 v243, 7, v0
    v_lshlrev_b32 v243, 1, v243
    v_add_u32 v243, s41, v243
    global_load_ushort v255, v243, s[18:19]
    v_lshrrev_b32 v15, 1, v0
    v_lshlrev_b32 v15, 13, v15
    v_and_b32 v242, 1, v0
    v_lshlrev_b32 v242, 4, v242
    v_add_u32 v15, v15, v242
    s_lshl_b32 s40, s30, 10
    s_lshl_b32 s41, s31, 5
    s_add_u32 s40, s40, s41
    v_add_u32 v15, s40, v15
    s_mov_b32 m0, 131072
    v_add_u32 v242, 0, v15
    global_load_lds_dwordx4 v242, s[10:11]
    s_mov_b32 m0, 132096
    v_add_u32 v242, 262144, v15
    global_load_lds_dwordx4 v242, s[10:11]
    s_mov_b32 m0, 133120
    v_add_u32 v242, 524288, v15
    global_load_lds_dwordx4 v242, s[10:11]
    s_mov_b32 m0, 134144
    v_add_u32 v242, 786432, v15
    global_load_lds_dwordx4 v242, s[10:11]
    s_mov_b32 m0, 135168
    v_add_u32 v242, 1048576, v15
    global_load_lds_dwordx4 v242, s[10:11]
    s_mov_b32 m0, 136192
    v_add_u32 v242, 1310720, v15
    global_load_lds_dwordx4 v242, s[10:11]
    s_mov_b32 m0, 137216
    v_add_u32 v242, 1572864, v15
    global_load_lds_dwordx4 v242, s[10:11]
    s_mov_b32 m0, 138240
    v_add_u32 v242, 1835008, v15
    global_load_lds_dwordx4 v242, s[10:11]
    s_mov_b32 m0, 139264
    v_add_u32 v242, 2097152, v15
    global_load_lds_dwordx4 v242, s[10:11]
    s_mov_b32 m0, 140288
    v_add_u32 v242, 2359296, v15
    global_load_lds_dwordx4 v242, s[10:11]
    s_mov_b32 m0, 141312
    v_add_u32 v242, 2621440, v15
    global_load_lds_dwordx4 v242, s[10:11]
    s_mov_b32 m0, 142336
    v_add_u32 v242, 2883584, v15
    global_load_lds_dwordx4 v242, s[10:11]
    s_mov_b32 m0, 143360
    v_add_u32 v242, 3145728, v15
    global_load_lds_dwordx4 v242, s[10:11]
    s_mov_b32 m0, 144384
    v_add_u32 v242, 3407872, v15
    global_load_lds_dwordx4 v242, s[10:11]
    s_lshl_b32 s40, s30, 5
    s_add_u32 s40, s40, s31
    s_lshl_b32 s41, s40, 12
    s_add_u32 s41, s41, 1048576
    v_add_u32 v6, s41, v5
    s_lshl_b32 s41, s40, 11
    s_add_u32 s41, s41, 2097152
    v_add_u32 v7, s41, v5
    v_add_u32 v8, 1048576, v7
    s_lshl_b32 s40, s30, 11
    s_lshl_b32 s41, s31, 6
    s_add_u32 s40, s40, s41
    v_add_u32 v9, s40, v5
    v_add_u32 v10, 65536, v9
    v_add_u32 v11, 131072, v9
    s_lshl_b32 s40, s31, 9
    s_lshl_b32 s41, s30, 6
    s_add_u32 s40, s40, s41
    s_add_u32 s40, s40, 196608
    v_add_u32 v12, s40, v5
    v_add_u32 v13, 65536, v12
    global_store_dwordx4 v6, v[80:83], s[28:29] offset:0
    global_store_dwordx4 v6, v[80:83], s[28:29] offset:1024
    s_mov_b64 exec, s[70:71]
    global_store_dwordx4 v6, v[80:83], s[28:29] offset:2048
    s_mov_b64 exec, -1
    global_store_dwordx4 v7, v[80:83], s[28:29] offset:0
    global_store_dwordx4 v7, v[80:83], s[28:29] offset:1024
    global_store_dwordx4 v8, v[80:83], s[28:29] offset:0
    global_store_dwordx4 v8, v[80:83], s[28:29] offset:1024
    s_mov_b64 exec, s[58:59]
    global_store_dwordx4 v9, v[80:83], s[28:29]
    global_store_dwordx4 v10, v[80:83], s[28:29]
    global_store_dwordx4 v11, v[80:83], s[28:29]
    s_mov_b64 exec, -1
    v_mov_b32 v244, 155216
    ds_write_b32 v244, v80
    s_waitcnt lgkmcnt(0)
    s_getreg_b32 s79, hwreg(HW_REG_XCC_ID)
    s_and_b32 s79, s79, 15
    s_lshl_b32 s40, s30, 4
    v_mov_b32 v15, s40
    s_mov_b32 s35, 0
    v_mov_b32 v244, 0
    v_mov_b32 v245, 0
    global_load_dwordx2 v[242:243], v15, s[26:27] sc1
    s_barrier
    v_mov_b32 v246, v15
    v_lshrrev_b32 v3, 4, v0
    v_and_b32 v4, 15, v0
    v_lshrrev_b32 v4, 2, v4
    v_lshlrev_b32 v15, 3, v3
    v_add_u32 v15, v15, v4
    v_lshlrev_b32 v250, 5, v15
    v_and_b32 v4, 3, v0
    v_lshlrev_b32 v4, 3, v4
    v_add_u32 v250, v250, v4
    v_add_u32 v250, 131072, v250
    v_lshlrev_b32 v251, 4, v15
    v_and_b32 v4, 1, v0
    v_lshlrev_b32 v4, 3, v4
    v_add_u32 v251, v251, v4
    v_add_u32 v251, 145408, v251
    v_add_u32 v252, 152576, v5
    v_lshlrev_b32 v253, 4, v3
    v_add_u32 v253, 152576, v253
    v_mov_b32 v15, v246
    s_branch L_nonce_nos
L_nonce:
    global_load_dwordx2 v[242:243], v15, s[26:27] sc1
    s_cmp_lt_u32 s35, 300
    s_cbranch_scc1 L_nonce_nos
    global_load_dwordx2 v[244:245], v15, s[26:27] offset:128 sc1
L_nonce_nos:
    s_add_u32 s35, s35, 1
    s_cmp_gt_u32 s35, 400000
    s_cbranch_scc1 L_abort
    s_waitcnt vmcnt(0)
    v_or_b32 v242, v242, v244
    v_or_b32 v243, v243, v245
    s_nop 0
    v_readfirstlane_b32 s46, v242
    v_readfirstlane_b32 s47, v243
    s_nop 1
    s_cmp_lt_i32 s47, 0
    s_cbranch_scc0 L_nonce
    v_mov_b32 v244, 155208
    ds_write_b64 v244, v[242:243]
    ds_read_b64_tr_b16 v[16:17], v250 offset:0
    ds_read_b64_tr_b16 v[18:19], v250 offset:128
    ds_read_b64_tr_b16 v[20:21], v250 offset:1024
    ds_read_b64_tr_b16 v[22:23], v250 offset:1152
    ds_read_b64_tr_b16 v[24:25], v250 offset:2048
    ds_read_b64_tr_b16 v[26:27], v250 offset:2176
    ds_read_b64_tr_b16 v[28:29], v250 offset:3072
    ds_read_b64_tr_b16 v[30:31], v250 offset:3200
    ds_read_b64_tr_b16 v[32:33], v250 offset:4096
    ds_read_b64_tr_b16 v[34:35], v250 offset:4224
    ds_read_b64_tr_b16 v[36:37], v250 offset:5120
    ds_read_b64_tr_b16 v[38:39], v250 offset:5248
    ds_read_b64_tr_b16 v[40:41], v250 offset:6144
    ds_read_b64_tr_b16 v[42:43], v250 offset:6272
    ds_read_b64_tr_b16 v[44:45], v250 offset:7168
    ds_read_b64_tr_b16 v[46:47], v250 offset:7296
    ds_read_b64_tr_b16 v[48:49], v250 offset:8192
    ds_read_b64_tr_b16 v[50:51], v250 offset:8320
    ds_read_b64_tr_b16 v[52:53], v250 offset:9216
    ds_read_b64_tr_b16 v[54:55], v250 offset:9344
    ds_read_b64_tr_b16 v[56:57], v250 offset:10240
    ds_read_b64_tr_b16 v[58:59], v250 offset:10368
    ds_read_b64_tr_b16 v[60:61], v250 offset:11264
    ds_read_b64_tr_b16 v[62:63], v250 offset:11392
    ds_read_b64_tr_b16 v[64:65], v250 offset:12288
    ds_read_b64_tr_b16 v[66:67], v250 offset:12416
    ds_read_b64_tr_b16 v[68:69], v250 offset:13312
    ds_read_b64_tr_b16 v[70:71], v250 offset:13440
    v_lshlrev_b32 v224, 16, v72
    v_and_b32 v225, 0xffff0000, v72
    v_lshlrev_b32 v226, 16, v73
    v_and_b32 v227, 0xffff0000, v73
    v_lshlrev_b32 v228, 16, v74
    v_and_b32 v229, 0xffff0000, v74
    v_lshlrev_b32 v230, 16, v75
    v_and_b32 v231, 0xffff0000, v75
    v_lshlrev_b32 v232, 16, v240
    v_and_b32 v233, 0xffff0000, v240
    v_lshlrev_b32 v234, 16, v241
    v_and_b32 v235, 0xffff0000, v241
    v_and_b32 v239, 0xffff0000, v237
    v_lshlrev_b32 v238, 16, v237
    v_and_b32 v237, 0xffff0000, v236
    v_lshlrev_b32 v236, 16, v236
    v_lshlrev_b32 v255, 16, v255
L_ctrl_layer:
    s_waitcnt lgkmcnt(0)
    v_add_f32 v72, v224, v225
    v_mul_f32 v73, v224, v224
    v_fmac_f32 v73, v225, v225
    v_add_f32 v72, v72, v226
    v_fmac_f32 v73, v226, v226
    v_add_f32 v72, v72, v227
    v_fmac_f32 v73, v227, v227
    v_add_f32 v72, v72, v228
    v_fmac_f32 v73, v228, v228
    v_add_f32 v72, v72, v229
    v_fmac_f32 v73, v229, v229
    v_add_f32 v72, v72, v230
    v_fmac_f32 v73, v230, v230
    v_add_f32 v72, v72, v231
    v_fmac_f32 v73, v231, v231
    s_nop 1
    v_add_f32_dpp v72, v72, v72 row_ror:8 row_mask:0xf bank_mask:0xf
    v_add_f32_dpp v73, v73, v73 row_ror:8 row_mask:0xf bank_mask:0xf
    s_nop 0
    v_add_f32_dpp v72, v72, v72 row_ror:4 row_mask:0xf bank_mask:0xf
    v_add_f32_dpp v73, v73, v73 row_ror:4 row_mask:0xf bank_mask:0xf
    s_nop 0
    v_add_f32_dpp v72, v72, v72 row_ror:2 row_mask:0xf bank_mask:0xf
    v_add_f32_dpp v73, v73, v73 row_ror:2 row_mask:0xf bank_mask:0xf
    s_nop 0
    v_add_f32_dpp v72, v72, v72 row_ror:1 row_mask:0xf bank_mask:0xf
    v_add_f32_dpp v73, v73, v73 row_ror:1 row_mask:0xf bank_mask:0xf
    s_nop 0
    v_mov_b32 v74, v72
    v_mov_b32 v75, v73
    s_nop 1
    v_permlane16_swap_b32 v72, v74
    v_permlane16_swap_b32 v73, v75
    s_nop 0
    v_add_f32 v72, v72, v74
    v_add_f32 v73, v73, v75
    v_mov_b32 v74, v72
    v_mov_b32 v75, v73
    s_nop 1
    v_permlane32_swap_b32 v72, v74
    v_permlane32_swap_b32 v73, v75
    s_nop 0
    v_add_f32 v72, v72, v74
    v_add_f32 v73, v73, v75
    v_mul_f32 v72, 0x3b124925, v72
    v_mul_f32 v73, 0x3b124925, v73
    v_fma_f32 v73, -v72, v72, v73
    v_max_f32 v73, 0, v73
    v_cvt_pk_bf16_f32 v74, v72, v73
    v_lshlrev_b32 v72, 16, v74
    v_and_b32 v73, 0xffff0000, v74
    v_add_f32 v73, 0x3727c5ac, v73
    v_cvt_pk_bf16_f32 v74, v73, v73
    v_lshlrev_b32 v73, 16, v74
    v_sqrt_f32 v73, v73
    s_nop 0
    v_cvt_pk_bf16_f32 v74, v73, v73
    v_lshlrev_b32 v73, 16, v74
    v_rcp_f32 v75, v73
    v_sub_f32 v76, v224, v72
    v_sub_f32 v77, v225, v72
    v_cvt_pk_bf16_f32 v74, v76, v77
    v_lshlrev_b32 v76, 16, v74
    v_and_b32 v77, 0xffff0000, v74
    v_mul_f32 v78, v76, v75
    v_mul_f32 v79, v77, v75
    v_fma_f32 v76, -v78, v73, v76
    v_fma_f32 v77, -v79, v73, v77
    v_fmac_f32 v78, v76, v75
    v_fmac_f32 v79, v77, v75
    v_cvt_pk_bf16_f32 v240, v78, v79
    v_sub_f32 v76, v226, v72
    v_sub_f32 v77, v227, v72
    v_cvt_pk_bf16_f32 v74, v76, v77
    v_lshlrev_b32 v76, 16, v74
    v_and_b32 v77, 0xffff0000, v74
    v_mul_f32 v78, v76, v75
    v_mul_f32 v79, v77, v75
    v_fma_f32 v76, -v78, v73, v76
    v_fma_f32 v77, -v79, v73, v77
    v_fmac_f32 v78, v76, v75
    v_fmac_f32 v79, v77, v75
    v_cvt_pk_bf16_f32 v241, v78, v79
    v_sub_f32 v76, v228, v72
    v_sub_f32 v77, v229, v72
    v_cvt_pk_bf16_f32 v74, v76, v77
    v_lshlrev_b32 v76, 16, v74
    v_and_b32 v77, 0xffff0000, v74
    v_mul_f32 v78, v76, v75
    v_mul_f32 v79, v77, v75
    v_fma_f32 v76, -v78, v73, v76
    v_fma_f32 v77, -v79, v73, v77
    v_fmac_f32 v78, v76, v75
    v_fmac_f32 v79, v77, v75
    v_cvt_pk_bf16_f32 v242, v78, v79
    v_sub_f32 v76, v230, v72
    v_sub_f32 v77, v231, v72
    v_cvt_pk_bf16_f32 v74, v76, v77
    v_lshlrev_b32 v76, 16, v74
    v_and_b32 v77, 0xffff0000, v74
    v_mul_f32 v78, v76, v75
    v_mul_f32 v79, v77, v75
    v_fma_f32 v76, -v78, v73, v76
    v_fma_f32 v77, -v79, v73, v77
    v_fmac_f32 v78, v76, v75
    v_fmac_f32 v79, v77, v75
    v_cvt_pk_bf16_f32 v243, v78, v79
    s_mov_b64 exec, s[56:57]
    ds_write_b128 v252, v[240:243]
    s_mov_b64 exec, -1
    s_waitcnt lgkmcnt(0)
    ds_read_b128 v[72:75], v253 offset:0
    ds_read_b128 v[76:79], v253 offset:64
    ds_read_b128 v[80:83], v253 offset:128
    ds_read_b128 v[84:87], v253 offset:192
    ds_read_b128 v[88:91], v253 offset:256
    ds_read_b128 v[92:95], v253 offset:320
    ds_read_b128 v[96:99], v253 offset:384
    ds_read_b128 v[100:103], v253 offset:448
    ds_read_b128 v[104:107], v253 offset:512
    ds_read_b128 v[108:111], v253 offset:576
    ds_read_b128 v[112:115], v253 offset:640
    ds_read_b128 v[116:119], v253 offset:704
    ds_read_b128 v[120:123], v253 offset:768
    ds_read_b128 v[124:127], v253 offset:832
    s_waitcnt lgkmcnt(12)
    v_mfma_f32_16x16x32_bf16 v[244:247], v[72:75], v[16:19], 0
    v_mfma_f32_16x16x32_bf16 v[244:247], v[76:79], v[20:23], v[244:247]
    s_waitcnt lgkmcnt(10)
    v_mfma_f32_16x16x32_bf16 v[244:247], v[80:83], v[24:27], v[244:247]
    v_mfma_f32_16x16x32_bf16 v[244:247], v[84:87], v[28:31], v[244:247]
    s_waitcnt lgkmcnt(8)
    v_mfma_f32_16x16x32_bf16 v[244:247], v[88:91], v[32:35], v[244:247]
    v_mfma_f32_16x16x32_bf16 v[244:247], v[92:95], v[36:39], v[244:247]
    s_waitcnt lgkmcnt(6)
    v_mfma_f32_16x16x32_bf16 v[244:247], v[96:99], v[40:43], v[244:247]
    v_mfma_f32_16x16x32_bf16 v[244:247], v[100:103], v[44:47], v[244:247]
    s_waitcnt lgkmcnt(4)
    v_mfma_f32_16x16x32_bf16 v[244:247], v[104:107], v[48:51], v[244:247]
    v_mfma_f32_16x16x32_bf16 v[244:247], v[108:111], v[52:55], v[244:247]
    s_waitcnt lgkmcnt(2)
    v_mfma_f32_16x16x32_bf16 v[244:247], v[112:115], v[56:59], v[244:247]
    v_mfma_f32_16x16x32_bf16 v[244:247], v[116:119], v[60:63], v[244:247]
    s_waitcnt lgkmcnt(0)
    v_mfma_f32_16x16x32_bf16 v[244:247], v[120:123], v[64:67], v[244:247]
    v_mfma_f32_16x16x32_bf16 v[244:247], v[124:127], v[68:71], v[244:247]
    s_nop 8
    v_cvt_pk_bf16_f32 v244, v244, v244
    v_lshlrev_b32 v244, 16, v244
    s_cmp_lg_u32 s76, 0
    s_cbranch_scc1 L_ctrl_pubq
    s_and_b32 s73, s47, 0xffff
    v_or_b32 v96, s73, v244
    v_mov_b32 v97, s46
    s_lshl_b32 s40, s30, 12
    s_add_u32 s40, s40, 393216
    s_lshl_b32 s41, s31, 7
    s_add_u32 s41, s41, s40
    v_lshlrev_b32 v98, 3, v0
    v_add_u32 v98, s41, v98
    v_lshlrev_b32 v91, 6, v0
    v_add_u32 v91, s40, v91
    s_mov_b64 exec, s[70:71]
    global_store_dwordx2 v98, v[96:97], s[28:29]
    s_mov_b64 exec, -1
    s_or_b32 s40, s46, s79
    v_mov_b32 v92, s40
    v_mov_b32 v93, s47
    s_lshl_b32 s40, s30, 8
    s_lshl_b32 s41, s31, 3
    s_add_u32 s40, s40, s41
    s_add_u32 s40, s40, 327680
    v_mov_b32 v95, s40
    s_mov_b64 exec, 1
    global_store_dwordx2 v95, v[92:93], s[28:29]
    s_mov_b64 exec, -1
    s_mov_b32 s35, 0
L_q1:
    global_load_dwordx4 v[72:75], v91, s[28:29] offset:0 sc1
    global_load_dwordx4 v[76:79], v91, s[28:29] offset:16 sc1
    global_load_dwordx4 v[80:83], v91, s[28:29] offset:32 sc1
    global_load_dwordx4 v[84:87], v91, s[28:29] offset:48 sc1
    s_add_u32 s35, s35, 1
    s_cmp_gt_u32 s35, 400000
    s_cbranch_scc1 L_abort
    s_cmp_lg_u32 s35, 300
    s_cbranch_scc1 L_q1_nos
    s_mov_b64 exec, s[70:71]
    global_store_dwordx2 v98, v[96:97], s[28:29] sc1
    s_mov_b64 exec, -1
    s_or_b32 s40, s46, s79
    v_mov_b32 v92, s40
    v_mov_b32 v93, s47
    s_lshl_b32 s40, s30, 8
    s_lshl_b32 s41, s31, 3
    s_add_u32 s40, s40, s41
    s_add_u32 s40, s40, 331776
    v_mov_b32 v95, s40
    s_mov_b64 exec, 1
    global_store_dwordx2 v95, v[92:93], s[28:29] sc1
    s_mov_b64 exec, -1
L_q1_nos:
    s_waitcnt vmcnt(0)
    v_xor_b32 v92, s46, v73
    v_xor_b32 v93, s46, v75
    v_or_b32 v92, v92, v93
    v_xor_b32 v93, s46, v77
    v_or_b32 v92, v92, v93
    v_xor_b32 v93, s46, v79
    v_or_b32 v92, v92, v93
    v_xor_b32 v93, s46, v81
    v_or_b32 v92, v92, v93
    v_xor_b32 v93, s46, v83
    v_or_b32 v92, v92, v93
    v_xor_b32 v93, s46, v85
    v_or_b32 v92, v92, v93
    v_xor_b32 v93, s46, v87
    v_or_b32 v92, v92, v93
    v_xor_b32 v93, s73, v72
    v_and_b32 v93, 0xffff, v93
    v_or_b32 v92, v92, v93
    v_xor_b32 v93, s73, v74
    v_and_b32 v93, 0xffff, v93
    v_or_b32 v92, v92, v93
    v_xor_b32 v93, s73, v76
    v_and_b32 v93, 0xffff, v93
    v_or_b32 v92, v92, v93
    v_xor_b32 v93, s73, v78
    v_and_b32 v93, 0xffff, v93
    v_or_b32 v92, v92, v93
    v_xor_b32 v93, s73, v80
    v_and_b32 v93, 0xffff, v93
    v_or_b32 v92, v92, v93
    v_xor_b32 v93, s73, v82
    v_and_b32 v93, 0xffff, v93
    v_or_b32 v92, v92, v93
    v_xor_b32 v93, s73, v84
    v_and_b32 v93, 0xffff, v93
    v_or_b32 v92, v92, v93
    v_xor_b32 v93, s73, v86
    v_and_b32 v93, 0xffff, v93
    v_or_b32 v92, v92, v93
    v_cmp_eq_u32 vcc, 0, v92
    s_nop 1
    s_cmp_eq_u64 vcc, exec
    s_cbranch_scc0 L_q1
    v_mov_b32 v73, v74
    v_mov_b32 v74, v76
    v_mov_b32 v75, v78
    v_mov_b32 v76, v80
    v_mov_b32 v77, v82
    v_mov_b32 v78, v84
    v_mov_b32 v79, v86
    v_mov_b32 v88, 155216
    v_mov_b32 v89, 1
    ds_write_b32 v88, v89
    s_branch L_ctrl_gotq
L_ctrl_pubq:
    v_or_b32 v244, s33, v244
    v_mul_u32_u24 v248, 12, v0
    v_sub_u32 v248, v9, v248
    s_lshl_b32 s40, s30, 11
    v_lshlrev_b32 v249, 5, v0
    v_add_u32 v249, s40, v249
    s_mov_b64 exec, s[70:71]
    s_cmp_eq_u32 s34, 1
    s_cbranch_scc1 L_f_33
    global_store_dword v248, v244, s[28:29] sc1
    s_branch L_e_34
L_f_33:
    global_store_dword v248, v244, s[28:29]
L_e_34:
    s_mov_b64 exec, -1
    s_mov_b32 s35, 0
L_poll_35:
    global_load_dwordx4 v[72:75], v249, s[28:29] sc1
    global_load_dwordx4 v[76:79], v249, s[28:29] offset:16 sc1
    s_add_u32 s35, s35, 1
    s_cmp_gt_u32 s35, 400000
    s_cbranch_scc1 L_abort
    s_waitcnt vmcnt(0)
    v_and_b32 v248, s33, v72
    v_and_b32 v248, v248, v73
    v_and_b32 v248, v248, v74
    v_and_b32 v248, v248, v75
    v_and_b32 v248, v248, v76
    v_and_b32 v248, v248, v77
    v_and_b32 v248, v248, v78
    v_and_b32 v248, v248, v79
    v_cmp_ne_u32 vcc, 0, v248
    s_nop 1
    s_cmp_eq_u64 vcc, exec
    s_cbranch_scc0 L_poll_35
L_ctrl_gotq:
    s_mov_b32 s3, 0x07060302
    v_perm_b32 v80, v73, v72, s3
    v_perm_b32 v81, v75, v74, s3
    v_perm_b32 v82, v77, v76, s3
    v_perm_b32 v83, v79, v78, s3
    v_add_u32 v15, 153600, v5
    ds_write_b128 v15, v[80:83]
    s_waitcnt lgkmcnt(0)
    s_barrier
    s_cmp_eq_u32 s76, 0
    s_cbranch_scc1 L_ctrl_b1
    ds_read_b64_tr_b16 v[16:17], v251 offset:0
    ds_read_b64_tr_b16 v[18:19], v251 offset:64
    ds_read_b64_tr_b16 v[20:21], v251 offset:512
    ds_read_b64_tr_b16 v[22:23], v251 offset:576
    ds_read_b64_tr_b16 v[24:25], v251 offset:1024
    ds_read_b64_tr_b16 v[26:27], v251 offset:1088
    ds_read_b64_tr_b16 v[28:29], v251 offset:1536
    ds_read_b64_tr_b16 v[30:31], v251 offset:1600
    ds_read_b64_tr_b16 v[32:33], v251 offset:2048
    ds_read_b64_tr_b16 v[34:35], v251 offset:2112
    ds_read_b64_tr_b16 v[36:37], v251 offset:2560
    ds_read_b64_tr_b16 v[38:39], v251 offset:2624
    ds_read_b64_tr_b16 v[40:41], v251 offset:3072
    ds_read_b64_tr_b16 v[42:43], v251 offset:3136
    ds_read_b64_tr_b16 v[44:45], v251 offset:3584
    ds_read_b64_tr_b16 v[46:47], v251 offset:3648
    ds_read_b64_tr_b16 v[48:49], v251 offset:4096
    ds_read_b64_tr_b16 v[50:51], v251 offset:4160
    ds_read_b64_tr_b16 v[52:53], v251 offset:4608
    ds_read_b64_tr_b16 v[54:55], v251 offset:4672
    ds_read_b64_tr_b16 v[56:57], v251 offset:5120
    ds_read_b64_tr_b16 v[58:59], v251 offset:5184
    ds_read_b64_tr_b16 v[60:61], v251 offset:5632
    ds_read_b64_tr_b16 v[62:63], v251 offset:5696
    ds_read_b64_tr_b16 v[64:65], v251 offset:6144
    ds_read_b64_tr_b16 v[66:67], v251 offset:6208
    ds_read_b64_tr_b16 v[68:69], v251 offset:6656
    ds_read_b64_tr_b16 v[70:71], v251 offset:6720
    s_barrier
    s_waitcnt lgkmcnt(0)
    s_barrier
    s_branch L_ctrl_l2
L_ctrl_b1:
    s_barrier
    s_lshl_b32 s40, s30, 8
    s_add_u32 s40, s40, 327680
    v_and_b32 v15, 31, v0
    v_lshlrev_b32 v15, 3, v15
    v_add_u32 v15, s40, v15
    v_add_u32 v86, 4096, v15
    s_mov_b32 s35, 0
    s_mov_b32 s73, 0
    v_mov_b32 v90, 0
    v_mov_b32 v91, 0
L_hello:
    global_load_dwordx2 v[88:89], v15, s[28:29] sc1
    s_cmp_eq_u32 s73, 0
    s_cbranch_scc1 L_hello_nos
    global_load_dwordx2 v[90:91], v86, s[28:29] sc1
L_hello_nos:
    s_add_u32 s35, s35, 1
    s_cmp_gt_u32 s35, 400000
    s_cbranch_scc1 L_abort
    s_waitcnt vmcnt(0)
    v_and_b32 v92, -16, v88
    v_xor_b32 v92, s46, v92
    v_xor_b32 v93, s47, v89
    v_or_b32 v92, v92, v93
    v_cmp_eq_u32 s[38:39], 0, v92
    v_and_b32 v92, -16, v90
    v_xor_b32 v92, s46, v92
    v_xor_b32 v93, s47, v91
    v_or_b32 v92, v92, v93
    v_cmp_eq_u32 vcc, 0, v92
    s_nop 1
    v_cndmask_b32 v88, v90, v88, s[38:39]
    s_or_b64 s[38:39], s[38:39], vcc
    v_and_b32 v88, 15, v88
    v_cmp_ne_u32 vcc, s79, v88
    s_nop 1
    s_and_b64 vcc, vcc, s[38:39]
    s_cmp_lg_u64 vcc, 0
    s_cbranch_scc1 L_slow
    s_cmp_eq_u64 s[38:39], exec
    s_cbranch_scc1 L_fast
    s_cmp_lt_u32 s35, 300
    s_cbranch_scc1 L_hello
    s_cmp_lg_u32 s73, 0
    s_cbranch_scc1 L_hello
    s_mov_b32 s73, 1
    s_mov_b64 exec, s[70:71]
    global_store_dwordx2 v98, v[96:97], s[28:29] sc1
    s_mov_b64 exec, -1
    s_or_b32 s40, s46, s79
    v_mov_b32 v92, s40
    v_mov_b32 v93, s47
    s_lshl_b32 s40, s30, 8
    s_lshl_b32 s41, s31, 3
    s_add_u32 s40, s40, s41
    s_add_u32 s40, s40, 331776
    v_mov_b32 v95, s40
    s_mov_b64 exec, 1
    global_store_dwordx2 v95, v[92:93], s[28:29] sc1
    s_mov_b64 exec, -1
    s_branch L_hello
L_slow:
    s_mov_b64 exec, s[70:71]
    global_store_dwordx2 v98, v[96:97], s[28:29] sc1
    s_mov_b64 exec, -1
    s_or_b32 s40, s46, s79
    v_mov_b32 v92, s40
    v_mov_b32 v93, s47
    s_lshl_b32 s40, s30, 8
    s_lshl_b32 s41, s31, 3
    s_add_u32 s40, s40, s41
    s_add_u32 s40, s40, 331776
    v_mov_b32 v95, s40
    s_mov_b64 exec, 1
    global_store_dwordx2 v95, v[92:93], s[28:29] sc1
    s_mov_b64 exec, -1
    v_mov_b32 v80, 0
    v_mov_b32 v81, 0
    v_mov_b32 v82, 0
    v_mov_b32 v83, 0
    global_store_dwordx4 v6, v[80:83], s[28:29] offset:0 sc1
    global_store_dwordx4 v6, v[80:83], s[28:29] offset:1024 sc1
    s_mov_b64 exec, s[70:71]
    global_store_dwordx4 v6, v[80:83], s[28:29] offset:2048 sc1
    s_mov_b64 exec, -1
    global_store_dwordx4 v7, v[80:83], s[28:29] offset:0 sc1
    global_store_dwordx4 v7, v[80:83], s[28:29] offset:1024 sc1
    global_store_dwordx4 v8, v[80:83], s[28:29] offset:0 sc1
    global_store_dwordx4 v8, v[80:83], s[28:29] offset:1024 sc1
    s_mov_b64 exec, s[58:59]
    global_store_dwordx4 v9, v[80:83], s[28:29] sc1
    global_store_dwordx4 v10, v[80:83], s[28:29] sc1
    global_store_dwordx4 v11, v[80:83], s[28:29] sc1
    s_mov_b64 exec, -1
    s_waitcnt vmcnt(0)
    s_or_b32 s40, s46, s79
    v_mov_b32 v92, s40
    v_mov_b32 v93, s47
    s_lshl_b32 s40, s30, 8
    s_lshl_b32 s41, s31, 3
    s_add_u32 s40, s40, s41
    s_add_u32 s40, s40, 335872
    v_mov_b32 v95, s40
    s_mov_b64 exec, 1
    global_store_dwordx2 v95, v[92:93], s[28:29] sc1
    s_mov_b64 exec, -1
    v_add_u32 v86, 8192, v15
    s_mov_b32 s35, 0
L_hello2:
    global_load_dwordx2 v[88:89], v86, s[28:29] sc1
    s_add_u32 s35, s35, 1
    s_cmp_gt_u32 s35, 400000
    s_cbranch_scc1 L_abort
    s_waitcnt vmcnt(0)
    v_and_b32 v92, -16, v88
    v_xor_b32 v92, s46, v92
    v_xor_b32 v93, s47, v89
    v_or_b32 v92, v92, v93
    v_cmp_eq_u32 vcc, 0, v92
    s_nop 1
    s_cmp_eq_u64 vcc, exec
    s_cbranch_scc0 L_hello2
    s_mov_b32 s34, 0
    s_branch L_modew
L_fast:
    s_mov_b32 s34, 1
L_modew:
    v_mov_b32 v88, 155200
    v_mov_b32 v89, s34
    ds_write_b32 v88, v89
    s_waitcnt lgkmcnt(0)
    s_barrier
    s_barrier
    v_add_u32 v15, 65536, v5
    ds_read_b128 v[128:131], v5 offset:0
    ds_read_b128 v[132:135], v5 offset:32768
    ds_read_b128 v[136:139], v15 offset:0
    ds_read_b128 v[140:143], v15 offset:32768
    ds_read_b128 v[144:147], v5 offset:1024
    ds_read_b128 v[148:151], v5 offset:33792
    ds_read_b128 v[152:155], v15 offset:1024
    ds_read_b128 v[156:159], v15 offset:33792
    ds_read_b128 v[160:163], v5 offset:2048
    ds_read_b128 v[164:167], v5 offset:34816
    ds_read_b128 v[168:171], v15 offset:2048
    ds_read_b128 v[172:175], v15 offset:34816
    ds_read_b128 v[176:179], v5 offset:3072
    ds_read_b128 v[180:183], v5 offset:35840
    ds_read_b128 v[184:187], v15 offset:3072
    ds_read_b128 v[188:191], v15 offset:35840
    ds_read_b128 v[192:195], v5 offset:4096
    ds_read_b128 v[196:199], v5 offset:36864
    ds_read_b128 v[200:203], v15 offset:4096
    ds_read_b128 v[204:207], v15 offset:36864
    ds_read_b128 v[208:211], v5 offset:5120
    ds_read_b128 v[212:215], v5 offset:37888
    ds_read_b128 v[216:219], v15 offset:5120
    ds_read_b128 v[220:223], v15 offset:37888
    s_waitcnt lgkmcnt(0)
    s_mov_b32 s73, 0x05040100
    s_mov_b32 s3, 0x07060302
    v_perm_b32 v248, v132, v128, s73
    v_perm_b32 v132, v132, v128, s3
    v_mov_b32 v128, v248
    v_perm_b32 v248, v133, v129, s73
    v_perm_b32 v133, v133, v129, s3
    v_mov_b32 v129, v248
    v_perm_b32 v248, v134, v130, s73
    v_perm_b32 v134, v134, v130, s3
    v_mov_b32 v130, v248
    v_perm_b32 v248, v135, v131, s73
    v_perm_b32 v135, v135, v131, s3
    v_mov_b32 v131, v248
    v_perm_b32 v248, v140, v136, s73
    v_perm_b32 v140, v140, v136, s3
    v_mov_b32 v136, v248
    v_perm_b32 v248, v141, v137, s73
    v_perm_b32 v141, v141, v137, s3
    v_mov_b32 v137, v248
    v_perm_b32 v248, v142, v138, s73
    v_perm_b32 v142, v142, v138, s3
    v_mov_b32 v138, v248
    v_perm_b32 v248, v143, v139, s73
    v_perm_b32 v143, v143, v139, s3
    v_mov_b32 v139, v248
    v_perm_b32 v248, v148, v144, s73
    v_perm_b32 v148, v148, v144, s3
    v_mov_b32 v144, v248
    v_perm_b32 v248, v149, v145, s73
    v_perm_b32 v149, v149, v145, s3
    v_mov_b32 v145, v248
    v_perm_b32 v248, v150, v146, s73
    v_perm_b32 v150, v150, v146, s3
    v_mov_b32 v146, v248
    v_perm_b32 v248, v151, v147, s73
    v_perm_b32 v151, v151, v147, s3
    v_mov_b32 v147, v248
    v_perm_b32 v248, v156, v152, s73
    v_perm_b32 v156, v156, v152, s3
    v_mov_b32 v152, v248
    v_perm_b32 v248, v157, v153, s73
    v_perm_b32 v157, v157, v153, s3
    v_mov_b32 v153, v248
    v_perm_b32 v248, v158, v154, s73
    v_perm_b32 v158, v158, v154, s3
    v_mov_b32 v154, v248
    v_perm_b32 v248, v159, v155, s73
    v_perm_b32 v159, v159, v155, s3
    v_mov_b32 v155, v248
    v_perm_b32 v248, v164, v160, s73
    v_perm_b32 v164, v164, v160, s3
    v_mov_b32 v160, v248
    v_perm_b32 v248, v165, v161, s73
    v_perm_b32 v165, v165, v161, s3
    v_mov_b32 v161, v248
    v_perm_b32 v248, v166, v162, s73
    v_perm_b32 v166, v166, v162, s3
    v_mov_b32 v162, v248
    v_perm_b32 v248, v167, v163, s73
    v_perm_b32 v167, v167, v163, s3
    v_mov_b32 v163, v248
    v_perm_b32 v248, v172, v168, s73
    v_perm_b32 v172, v172, v168, s3
    v_mov_b32 v168, v248
    v_perm_b32 v248, v173, v169, s73
    v_perm_b32 v173, v173, v169, s3
    v_mov_b32 v169, v248
    v_perm_b32 v248, v174, v170, s73
    v_perm_b32 v174, v174, v170, s3
    v_mov_b32 v170, v248
    v_perm_b32 v248, v175, v171, s73
    v_perm_b32 v175, v175, v171, s3
    v_mov_b32 v171, v248
    v_perm_b32 v248, v180, v176, s73
    v_perm_b32 v180, v180, v176, s3
    v_mov_b32 v176, v248
    v_perm_b32 v248, v181, v177, s73
    v_perm_b32 v181, v181, v177, s3
    v_mov_b32 v177, v248
    v_perm_b32 v248, v182, v178, s73
    v_perm_b32 v182, v182, v178, s3
    v_mov_b32 v178, v248
    v_perm_b32 v248, v183, v179, s73
    v_perm_b32 v183, v183, v179, s3
    v_mov_b32 v179, v248
    v_perm_b32 v248, v188, v184, s73
    v_perm_b32 v188, v188, v184, s3
    v_mov_b32 v184, v248
    v_perm_b32 v248, v189, v185, s73
    v_perm_b32 v189, v189, v185, s3
    v_mov_b32 v185, v248
    v_perm_b32 v248, v190, v186, s73
    v_perm_b32 v190, v190, v186, s3
    v_mov_b32 v186, v248
    v_perm_b32 v248, v191, v187, s73
    v_perm_b32 v191, v191, v187, s3
    v_mov_b32 v187, v248
    v_perm_b32 v248, v196, v192, s73
    v_perm_b32 v196, v196, v192, s3
    v_mov_b32 v192, v248
    v_perm_b32 v248, v197, v193, s73
    v_perm_b32 v197, v197, v193, s3
    v_mov_b32 v193, v248
    v_perm_b32 v248, v198, v194, s73
    v_perm_b32 v198, v198, v194, s3
    v_mov_b32 v194, v248
    v_perm_b32 v248, v199, v195, s73
    v_perm_b32 v199, v199, v195, s3
    v_mov_b32 v195, v248
    v_perm_b32 v248, v204, v200, s73
    v_perm_b32 v204, v204, v200, s3
    v_mov_b32 v200, v248
    v_perm_b32 v248, v205, v201, s73
    v_perm_b32 v205, v205, v201, s3
    v_mov_b32 v201, v248
    v_perm_b32 v248, v206, v202, s73
    v_perm_b32 v206, v206, v202, s3
    v_mov_b32 v202, v248
    v_perm_b32 v248, v207, v203, s73
    v_perm_b32 v207, v207, v203, s3
    v_mov_b32 v203, v248
    v_perm_b32 v248, v212, v208, s73
    v_perm_b32 v212, v212, v208, s3
    v_mov_b32 v208, v248
    v_perm_b32 v248, v213, v209, s73
    v_perm_b32 v213, v213, v209, s3
    v_mov_b32 v209, v248
    v_perm_b32 v248, v214, v210, s73
    v_perm_b32 v214, v214, v210, s3
    v_mov_b32 v210, v248
    v_perm_b32 v248, v215, v211, s73
    v_perm_b32 v215, v215, v211, s3
    v_mov_b32 v211, v248
    v_perm_b32 v248, v220, v216, s73
    v_perm_b32 v220, v220, v216, s3
    v_mov_b32 v216, v248
    v_perm_b32 v248, v221, v217, s73
    v_perm_b32 v221, v221, v217, s3
    v_mov_b32 v217, v248
    v_perm_b32 v248, v222, v218, s73
    v_perm_b32 v222, v222, v218, s3
    v_mov_b32 v218, v248
    v_perm_b32 v248, v223, v219, s73
    v_perm_b32 v223, v223, v219, s3
    v_mov_b32 v219, v248
    ds_read_b64_tr_b16 v[16:17], v251 offset:0
    ds_read_b64_tr_b16 v[18:19], v251 offset:64
    ds_read_b64_tr_b16 v[20:21], v251 offset:512
    ds_read_b64_tr_b16 v[22:23], v251 offset:576
    ds_read_b64_tr_b16 v[24:25], v251 offset:1024
    ds_read_b64_tr_b16 v[26:27], v251 offset:1088
    ds_read_b64_tr_b16 v[28:29], v251 offset:1536
    ds_read_b64_tr_b16 v[30:31], v251 offset:1600
    ds_read_b64_tr_b16 v[32:33], v251 offset:2048
    ds_read_b64_tr_b16 v[34:35], v251 offset:2112
    ds_read_b64_tr_b16 v[36:37], v251 offset:2560
    ds_read_b64_tr_b16 v[38:39], v251 offset:2624
    ds_read_b64_tr_b16 v[40:41], v251 offset:3072
    ds_read_b64_tr_b16 v[42:43], v251 offset:3136
    ds_read_b64_tr_b16 v[44:45], v251 offset:3584
    ds_read_b64_tr_b16 v[46:47], v251 offset:3648
    ds_read_b64_tr_b16 v[48:49], v251 offset:4096
    ds_read_b64_tr_b16 v[50:51], v251 offset:4160
    ds_read_b64_tr_b16 v[52:53], v251 offset:4608
    ds_read_b64_tr_b16 v[54:55], v251 offset:4672
    ds_read_b64_tr_b16 v[56:57], v251 offset:5120
    ds_read_b64_tr_b16 v[58:59], v251 offset:5184
    ds_read_b64_tr_b16 v[60:61], v251 offset:5632
    ds_read_b64_tr_b16 v[62:63], v251 offset:5696
    ds_read_b64_tr_b16 v[64:65], v251 offset:6144
    ds_read_b64_tr_b16 v[66:67], v251 offset:6208
    ds_read_b64_tr_b16 v[68:69], v251 offset:6656
    ds_read_b64_tr_b16 v[70:71], v251 offset:6720
L_ctrl_l2:
    v_lshrrev_b32 v15, 2, v0
    v_lshlrev_b32 v15, 3, v15
    v_sub_u32 v15, v15, v5
    v_add_u32 v15, v15, v6
    s_mov_b32 s35, 0
L_poll_36:
    global_load_dwordx4 v[72:75], v6, s[28:29] sc1
    global_load_dwordx4 v[80:83], v6, s[28:29] offset:1024 sc1
    global_load_dwordx2 v[84:85], v15, s[28:29] offset:2048 sc1
    global_load_dwordx2 v[86:87], v15, s[28:29] offset:2176 sc1
    s_add_u32 s35, s35, 1
    s_cmp_gt_u32 s35, 400000
    s_cbranch_scc1 L_abort
    s_waitcnt vmcnt(0)
    v_and_b32 v248, s33, v72
    v_and_b32 v248, v248, v80
    v_and_b32 v248, v248, v84
    v_and_b32 v248, v248, v86
    v_cmp_ne_u32 vcc, 0, v248
    s_nop 1
    s_cmp_eq_u64 vcc, exec
    s_cbranch_scc0 L_poll_36
    v_max_f32 v88, v84, v86
    s_nop 1
    v_max_f32_dpp v88, v88, v88 row_ror:4 row_mask:0xf bank_mask:0xf
    s_nop 1
    v_max_f32_dpp v88, v88, v88 row_ror:8 row_mask:0xf bank_mask:0xf
    s_nop 1
    v_mov_b32 v92, v88
    s_nop 1
    v_permlane16_swap_b32 v88, v92
    s_nop 0
    v_max_f32 v88, v88, v92
    v_mov_b32 v92, v88
    s_nop 1
    v_permlane32_swap_b32 v88, v92
    s_nop 0
    v_max_f32 v88, v88, v92
    v_sub_f32 v89, v84, v88
    v_sub_f32 v90, v86, v88
    v_mul_f32 v89, s72, v89
    v_mul_f32 v90, s72, v90
    v_exp_f32 v89, v89
    v_exp_f32 v90, v90
    s_nop 0
    v_mul_f32 v91, v89, v85
    v_fmac_f32 v91, v90, v87
    v_mul_f32 v72, v89, v72
    v_fmac_f32 v72, v90, v80
    v_mul_f32 v73, v89, v73
    v_fmac_f32 v73, v90, v81
    v_mul_f32 v74, v89, v74
    v_fmac_f32 v74, v90, v82
    v_mul_f32 v75, v89, v75
    v_fmac_f32 v75, v90, v83
    s_nop 1
    v_add_f32_dpp v91, v91, v91 row_ror:4 row_mask:0xf bank_mask:0xf
    v_add_f32_dpp v72, v72, v72 row_ror:4 row_mask:0xf bank_mask:0xf
    v_add_f32_dpp v73, v73, v73 row_ror:4 row_mask:0xf bank_mask:0xf
    v_add_f32_dpp v74, v74, v74 row_ror:4 row_mask:0xf bank_mask:0xf
    v_add_f32_dpp v75, v75, v75 row_ror:4 row_mask:0xf bank_mask:0xf
    v_add_f32_dpp v91, v91, v91 row_ror:8 row_mask:0xf bank_mask:0xf
    v_add_f32_dpp v72, v72, v72 row_ror:8 row_mask:0xf bank_mask:0xf
    v_add_f32_dpp v73, v73, v73 row_ror:8 row_mask:0xf bank_mask:0xf
    v_add_f32_dpp v74, v74, v74 row_ror:8 row_mask:0xf bank_mask:0xf
    v_add_f32_dpp v75, v75, v75 row_ror:8 row_mask:0xf bank_mask:0xf
    v_mov_b32 v92, v91
    v_mov_b32 v93, v72
    v_mov_b32 v94, v73
    v_mov_b32 v95, v74
    v_mov_b32 v96, v75
    s_nop 1
    v_permlane16_swap_b32 v91, v92
    v_permlane16_swap_b32 v72, v93
    v_permlane16_swap_b32 v73, v94
    v_permlane16_swap_b32 v74, v95
    v_permlane16_swap_b32 v75, v96
    s_nop 0
    v_add_f32 v91, v91, v92
    v_add_f32 v72, v72, v93
    v_add_f32 v73, v73, v94
    v_add_f32 v74, v74, v95
    v_add_f32 v75, v75, v96
    v_mov_b32 v92, v91
    v_mov_b32 v93, v72
    v_mov_b32 v94, v73
    v_mov_b32 v95, v74
    v_mov_b32 v96, v75
    s_nop 1
    v_permlane32_swap_b32 v91, v92
    v_permlane32_swap_b32 v72, v93
    v_permlane32_swap_b32 v73, v94
    v_permlane32_swap_b32 v74, v95
    v_permlane32_swap_b32 v75, v96
    s_nop 0
    v_add_f32 v91, v91, v92
    v_add_f32 v72, v72, v93
    v_add_f32 v73, v73, v94
    v_add_f32 v74, v74, v95
    v_add_f32 v75, v75, v96
    v_rcp_f32 v91, v91
    s_nop 0
    v_mul_f32 v72, v72, v91
    v_mul_f32 v73, v73, v91
    v_mul_f32 v74, v74, v91
    v_mul_f32 v75, v75, v91
    v_cvt_pk_bf16_f32 v76, v72, v73
    v_cvt_pk_bf16_f32 v77, v74, v75
    s_nop 0
    v_readlane_b32 s48, v76, 0
    v_readlane_b32 s49, v77, 0
    v_readlane_b32 s50, v76, 1
    v_readlane_b32 s51, v77, 1
    v_readlane_b32 s52, v76, 2
    v_readlane_b32 s53, v77, 2
    v_readlane_b32 s54, v76, 3
    v_readlane_b32 s55, v77, 3
    s_nop 1
    v_dot2_f32_bf16 v96, s48, v128, 0
    v_dot2_f32_bf16 v97, s48, v132, 0
    v_dot2_f32_bf16 v98, s48, v129, 0
    v_dot2_f32_bf16 v99, s48, v133, 0
    v_dot2_f32_bf16 v100, s48, v130, 0
    v_dot2_f32_bf16 v101, s48, v134, 0
    v_dot2_f32_bf16 v102, s48, v131, 0
    v_dot2_f32_bf16 v103, s48, v135, 0
    v_dot2_f32_bf16 v96, s49, v136, v96
    v_dot2_f32_bf16 v97, s49, v140, v97
    v_dot2_f32_bf16 v98, s49, v137, v98
    v_dot2_f32_bf16 v99, s49, v141, v99
    v_dot2_f32_bf16 v100, s49, v138, v100
    v_dot2_f32_bf16 v101, s49, v142, v101
    v_dot2_f32_bf16 v102, s49, v139, v102
    v_dot2_f32_bf16 v103, s49, v143, v103
    v_dot2_f32_bf16 v96, s50, v144, v96
    v_dot2_f32_bf16 v97, s50, v148, v97
    v_dot2_f32_bf16 v98, s50, v145, v98
    v_dot2_f32_bf16 v99, s50, v149, v99
    v_dot2_f32_bf16 v100, s50, v146, v100
    v_dot2_f32_bf16 v101, s50, v150, v101
    v_dot2_f32_bf16 v102, s50, v147, v102
    v_dot2_f32_bf16 v103, s50, v151, v103
    v_dot2_f32_bf16 v96, s51, v152, v96
    v_dot2_f32_bf16 v97, s51, v156, v97
    v_dot2_f32_bf16 v98, s51, v153, v98
    v_dot2_f32_bf16 v99, s51, v157, v99
    v_dot2_f32_bf16 v100, s51, v154, v100
    v_dot2_f32_bf16 v101, s51, v158, v101
    v_dot2_f32_bf16 v102, s51, v155, v102
    v_dot2_f32_bf16 v103, s51, v159, v103
    v_dot2_f32_bf16 v96, s52, v160, v96
    v_dot2_f32_bf16 v97, s52, v164, v97
    v_dot2_f32_bf16 v98, s52, v161, v98
    v_dot2_f32_bf16 v99, s52, v165, v99
    v_dot2_f32_bf16 v100, s52, v162, v100
    v_dot2_f32_bf16 v101, s52, v166, v101
    v_dot2_f32_bf16 v102, s52, v163, v102
    v_dot2_f32_bf16 v103, s52, v167, v103
    v_dot2_f32_bf16 v96, s53, v168, v96
    v_dot2_f32_bf16 v97, s53, v172, v97
    v_dot2_f32_bf16 v98, s53, v169, v98
    v_dot2_f32_bf16 v99, s53, v173, v99
    v_dot2_f32_bf16 v100, s53, v170, v100
    v_dot2_f32_bf16 v101, s53, v174, v101
    v_dot2_f32_bf16 v102, s53, v171, v102
    v_dot2_f32_bf16 v103, s53, v175, v103
    v_dot2_f32_bf16 v96, s54, v176, v96
    v_dot2_f32_bf16 v97, s54, v180, v97
    v_dot2_f32_bf16 v98, s54, v177, v98
    v_dot2_f32_bf16 v99, s54, v181, v99
    v_dot2_f32_bf16 v100, s54, v178, v100
    v_dot2_f32_bf16 v101, s54, v182, v101
    v_dot2_f32_bf16 v102, s54, v179, v102
    v_dot2_f32_bf16 v103, s54, v183, v103
    v_dot2_f32_bf16 v96, s55, v184, v96
    v_dot2_f32_bf16 v97, s55, v188, v97
    v_dot2_f32_bf16 v98, s55, v185, v98
    v_dot2_f32_bf16 v99, s55, v189, v99
    v_dot2_f32_bf16 v100, s55, v186, v100
    v_dot2_f32_bf16 v101, s55, v190, v101
    v_dot2_f32_bf16 v102, s55, v187, v102
    v_dot2_f32_bf16 v103, s55, v191, v103
    s_nop 2
    v_bfi_b32 v96, 3, s33, v96
    v_bfi_b32 v100, 3, s33, v100
    s_lshl_b32 s40, s30, 16
    s_lshl_b32 s41, s31, 6
    s_add_u32 s40, s40, s41
    s_add_u32 s40, s40, 2097152
    v_lshrrev_b32 v15, 1, v0
    v_lshlrev_b32 v15, 11, v15
    v_and_b32 v248, 1, v0
    v_lshlrev_b32 v248, 5, v248
    v_add3_u32 v15, v15, v248, s40
    s_mov_b64 exec, s[56:57]
    s_cmp_eq_u32 s34, 1
    s_cbranch_scc1 L_f_37
    global_store_dwordx4 v15, v[96:99], s[28:29] sc1
    global_store_dwordx4 v15, v[100:103], s[28:29] offset:16 sc1
    s_branch L_e_38
L_f_37:
    global_store_dwordx4 v15, v[96:99], s[28:29]
    global_store_dwordx4 v15, v[100:103], s[28:29] offset:16
L_e_38:
    s_mov_b64 exec, -1
    s_cmp_ge_u32 s31, 28
    s_cbranch_scc1 L_ctrl_skipmlp
    s_mov_b32 s35, 0
L_poll_39:
    global_load_dwordx4 v[72:75], v7, s[28:29] sc1
    global_load_dwordx4 v[76:79], v7, s[28:29] offset:1024 sc1
    s_add_u32 s35, s35, 1
    s_cmp_gt_u32 s35, 400000
    s_cbranch_scc1 L_abort
    s_waitcnt vmcnt(0)
    v_and_b32 v248, s33, v72
    v_and_b32 v248, v248, v76
    v_cmp_ne_u32 vcc, 0, v248
    s_nop 1
    s_cmp_eq_u64 vcc, exec
    s_cbranch_scc0 L_poll_39
    v_add_f32 v72, v72, v76
    v_add_f32 v73, v73, v77
    v_add_f32 v74, v74, v78
    v_add_f32 v75, v75, v79
    s_nop 1
    v_add_f32_dpp v72, v72, v72 row_ror:4 row_mask:0xf bank_mask:0xf
    v_add_f32_dpp v73, v73, v73 row_ror:4 row_mask:0xf bank_mask:0xf
    v_add_f32_dpp v74, v74, v74 row_ror:4 row_mask:0xf bank_mask:0xf
    v_add_f32_dpp v75, v75, v75 row_ror:4 row_mask:0xf bank_mask:0xf
    v_add_f32_dpp v72, v72, v72 row_ror:8 row_mask:0xf bank_mask:0xf
    v_add_f32_dpp v73, v73, v73 row_ror:8 row_mask:0xf bank_mask:0xf
    v_add_f32_dpp v74, v74, v74 row_ror:8 row_mask:0xf bank_mask:0xf
    v_add_f32_dpp v75, v75, v75 row_ror:8 row_mask:0xf bank_mask:0xf
    v_mov_b32 v80, v72
    v_mov_b32 v81, v73
    v_mov_b32 v82, v74
    v_mov_b32 v83, v75
    s_nop 1
    v_permlane16_swap_b32 v72, v80
    v_permlane16_swap_b32 v73, v81
    v_permlane16_swap_b32 v74, v82
    v_permlane16_swap_b32 v75, v83
    s_nop 0
    v_add_f32 v72, v72, v80
    v_add_f32 v73, v73, v81
    v_add_f32 v74, v74, v82
    v_add_f32 v75, v75, v83
    v_mov_b32 v80, v72
    v_mov_b32 v81, v73
    v_mov_b32 v82, v74
    v_mov_b32 v83, v75
    s_nop 1
    v_permlane32_swap_b32 v72, v80
    v_permlane32_swap_b32 v73, v81
    v_permlane32_swap_b32 v74, v82
    v_permlane32_swap_b32 v75, v83
    s_nop 0
    v_add_f32 v72, v72, v80
    v_add_f32 v73, v73, v81
    v_add_f32 v74, v74, v82
    v_add_f32 v75, v75, v83
    v_bfi_b32 v72, 3, s33, v72
    s_mov_b64 exec, s[58:59]
    global_store_dwordx4 v12, v[72:75], s[28:29] sc1
    s_mov_b64 exec, -1
    s_cmp_lg_u32 s76, 0
    s_cbranch_scc1 L_xr_ok
    v_lshlrev_b32 v15, 4, v0
    s_lshl_b32 s40, s31, 6
    s_add_u32 s40, s40, 339968
    v_lshlrev_b32 v90, 3, v0
    v_add_u32 v90, s40, v90
    s_mov_b64 exec, s[68:69]
    s_mov_b32 s35, 0
L_xr:
    global_load_dwordx2 v[84:85], v15, s[26:27] offset:128 sc1
    global_load_dwordx2 v[86:87], v90, s[28:29] sc1
    s_add_u32 s35, s35, 1
    s_cmp_gt_u32 s35, 400000
    s_cbranch_scc1 L_abort
    s_waitcnt vmcnt(0)
    v_xor_b32 v88, v84, v86
    v_xor_b32 v89, v85, v87
    v_or_b32 v88, v88, v89
    v_cmp_eq_u32 s[38:39], 0, v88
    v_cmp_gt_i32 vcc, 0, v85
    s_nop 1
    s_and_b64 vcc, vcc, s[38:39]
    s_cmp_eq_u64 vcc, exec
    s_cbranch_scc0 L_xr
    s_mov_b64 exec, -1
L_xr_ok:
    s_lshl_b32 s40, s31, 9
    s_add_u32 s40, s40, 196608
    v_add_u32 v15, s40, v5
    v_mov_b32 v76, 0
    v_mov_b32 v77, 0
    v_mov_b32 v78, 0
    v_mov_b32 v79, 0
    s_mov_b64 exec, s[60:61]
    s_mov_b32 s35, 0
    global_load_dwordx4 v[112:115], v15, s[28:29] sc1
    global_load_dwordx4 v[116:119], v15, s[28:29] sc1
L_xs_40:
    s_add_u32 s35, s35, 1
    s_cmp_gt_u32 s35, 400000
    s_cbranch_scc1 L_abort
    s_waitcnt vmcnt(1)
    v_and_b32 v248, s33, v112
    v_cmp_ne_u32 vcc, 0, v248
    s_nop 1
    s_cmp_eq_u64 vcc, exec
    s_cbranch_scc1 L_xsd_42
    global_load_dwordx4 v[112:115], v15, s[28:29] sc1
    s_waitcnt vmcnt(1)
    v_and_b32 v248, s33, v116
    v_cmp_ne_u32 vcc, 0, v248
    s_nop 1
    s_cmp_eq_u64 vcc, exec
    s_cbranch_scc1 L_xsd_43
    global_load_dwordx4 v[116:119], v15, s[28:29] sc1
    s_branch L_xs_40
L_xsd_42:
    v_mov_b32 v76, v112
    v_mov_b32 v77, v113
    v_mov_b32 v78, v114
    v_mov_b32 v79, v115
    s_branch L_xse_41
L_xsd_43:
    v_mov_b32 v76, v116
    v_mov_b32 v77, v117
    v_mov_b32 v78, v118
    v_mov_b32 v79, v119
    s_branch L_xse_41
L_xse_41:
    s_mov_b64 exec, -1
    s_nop 1
    v_add_f32_dpp v76, v76, v76 row_ror:4 row_mask:0xf bank_mask:0xf
    v_add_f32_dpp v77, v77, v77 row_ror:4 row_mask:0xf bank_mask:0xf
    v_add_f32_dpp v78, v78, v78 row_ror:4 row_mask:0xf bank_mask:0xf
    v_add_f32_dpp v79, v79, v79 row_ror:4 row_mask:0xf bank_mask:0xf
    v_add_f32_dpp v76, v76, v76 row_ror:8 row_mask:0xf bank_mask:0xf
    v_add_f32_dpp v77, v77, v77 row_ror:8 row_mask:0xf bank_mask:0xf
    v_add_f32_dpp v78, v78, v78 row_ror:8 row_mask:0xf bank_mask:0xf
    v_add_f32_dpp v79, v79, v79 row_ror:8 row_mask:0xf bank_mask:0xf
    v_mov_b32 v80, v76
    v_mov_b32 v81, v77
    v_mov_b32 v82, v78
    v_mov_b32 v83, v79
    s_nop 1
    v_permlane16_swap_b32 v76, v80
    v_permlane16_swap_b32 v77, v81
    v_permlane16_swap_b32 v78, v82
    v_permlane16_swap_b32 v79, v83
    s_nop 0
    v_add_f32 v76, v76, v80
    v_add_f32 v77, v77, v81
    v_add_f32 v78, v78, v82
    v_add_f32 v79, v79, v83
    v_cvt_pk_bf16_f32 v248, v76, v77
    v_lshlrev_b32 v76, 16, v248
    v_and_b32 v77, 0xffff0000, v248
    v_cvt_pk_bf16_f32 v248, v78, v79
    v_lshlrev_b32 v78, 16, v248
    v_and_b32 v79, 0xffff0000, v248
    v_add_f32 v232, v232, v76
    v_add_f32 v233, v233, v77
    v_add_f32 v234, v234, v78
    v_add_f32 v235, v235, v79
    v_cvt_pk_bf16_f32 v248, v232, v233
    v_lshlrev_b32 v232, 16, v248
    v_and_b32 v233, 0xffff0000, v248
    v_cvt_pk_bf16_f32 v248, v234, v235
    v_lshlrev_b32 v234, 16, v248
    v_and_b32 v235, 0xffff0000, v248
    v_or_b32 v76, s33, v232
    v_mov_b32 v77, v233
    v_mov_b32 v78, v234
    v_mov_b32 v79, v235
    s_mov_b64 exec, s[58:59]
    s_cmp_eq_u32 s34, 1
    s_cbranch_scc1 L_f_44
    global_store_dwordx4 v10, v[76:79], s[28:29] sc1
    s_branch L_e_45
L_f_44:
    global_store_dwordx4 v10, v[76:79], s[28:29]
L_e_45:
    s_mov_b64 exec, -1
    s_lshl_b32 s40, s30, 11
    s_add_u32 s40, s40, 65536
    v_lshlrev_b32 v15, 5, v0
    v_add_u32 v15, s40, v15
    s_mov_b64 exec, s[56:57]
    s_mov_b32 s35, 0
L_poll_46:
    global_load_dwordx4 v[224:227], v15, s[28:29] sc1
    global_load_dwordx4 v[228:231], v15, s[28:29] offset:16 sc1
    s_add_u32 s35, s35, 1
    s_cmp_gt_u32 s35, 400000
    s_cbranch_scc1 L_abort
    s_waitcnt vmcnt(0)
    v_and_b32 v248, s33, v224
    v_and_b32 v248, v248, v228
    v_cmp_ne_u32 vcc, 0, v248
    s_nop 1
    s_cmp_eq_u64 vcc, exec
    s_cbranch_scc0 L_poll_46
    v_and_b32 v224, 0xffff0000, v224
    v_and_b32 v228, 0xffff0000, v228
    s_mov_b64 exec, -1
    v_add_f32 v72, v224, v225
    v_mul_f32 v73, v224, v224
    v_fmac_f32 v73, v225, v225
    v_add_f32 v72, v72, v226
    v_fmac_f32 v73, v226, v226
    v_add_f32 v72, v72, v227
    v_fmac_f32 v73, v227, v227
    v_add_f32 v72, v72, v228
    v_fmac_f32 v73, v228, v228
    v_add_f32 v72, v72, v229
    v_fmac_f32 v73, v229, v229
    v_add_f32 v72, v72, v230
    v_fmac_f32 v73, v230, v230
    v_add_f32 v72, v72, v231
    v_fmac_f32 v73, v231, v231
    s_nop 1
    v_add_f32_dpp v72, v72, v72 row_ror:8 row_mask:0xf bank_mask:0xf
    v_add_f32_dpp v73, v73, v73 row_ror:8 row_mask:0xf bank_mask:0xf
    s_nop 0
    v_add_f32_dpp v72, v72, v72 row_ror:4 row_mask:0xf bank_mask:0xf
    v_add_f32_dpp v73, v73, v73 row_ror:4 row_mask:0xf bank_mask:0xf
    s_nop 0
    v_add_f32_dpp v72, v72, v72 row_ror:2 row_mask:0xf bank_mask:0xf
    v_add_f32_dpp v73, v73, v73 row_ror:2 row_mask:0xf bank_mask:0xf
    s_nop 0
    v_add_f32_dpp v72, v72, v72 row_ror:1 row_mask:0xf bank_mask:0xf
    v_add_f32_dpp v73, v73, v73 row_ror:1 row_mask:0xf bank_mask:0xf
    s_nop 0
    v_mov_b32 v74, v72
    v_mov_b32 v75, v73
    s_nop 1
    v_permlane16_swap_b32 v72, v74
    v_permlane16_swap_b32 v73, v75
    s_nop 0
    v_add_f32 v72, v72, v74
    v_add_f32 v73, v73, v75
    v_mov_b32 v74, v72
    v_mov_b32 v75, v73
    s_nop 1
    v_permlane32_swap_b32 v72, v74
    v_permlane32_swap_b32 v73, v75
    s_nop 0
    v_add_f32 v72, v72, v74
    v_add_f32 v73, v73, v75
    v_mul_f32 v72, 0x3b124925, v72
    v_mul_f32 v73, 0x3b124925, v73
    v_fma_f32 v73, -v72, v72, v73
    v_max_f32 v73, 0, v73
    v_cvt_pk_bf16_f32 v74, v72, v73
    v_lshlrev_b32 v72, 16, v74
    v_and_b32 v73, 0xffff0000, v74
    v_add_f32 v73, 0x3727c5ac, v73
    v_cvt_pk_bf16_f32 v74, v73, v73
    v_lshlrev_b32 v73, 16, v74
    v_sqrt_f32 v73, v73
    s_nop 0
    v_cvt_pk_bf16_f32 v74, v73, v73
    v_lshlrev_b32 v73, 16, v74
    v_rcp_f32 v75, v73
    v_sub_f32 v76, v224, v72
    v_sub_f32 v77, v225, v72
    v_cvt_pk_bf16_f32 v74, v76, v77
    v_lshlrev_b32 v76, 16, v74
    v_and_b32 v77, 0xffff0000, v74
    v_mul_f32 v78, v76, v75
    v_mul_f32 v79, v77, v75
    v_fma_f32 v76, -v78, v73, v76
    v_fma_f32 v77, -v79, v73, v77
    v_fmac_f32 v78, v76, v75
    v_fmac_f32 v79, v77, v75
    v_cvt_pk_bf16_f32 v240, v78, v79
    v_lshlrev_b32 v88, 16, v240
    v_and_b32 v89, 0xffff0000, v240
    v_sub_f32 v76, v226, v72
    v_sub_f32 v77, v227, v72
    v_cvt_pk_bf16_f32 v74, v76, v77
    v_lshlrev_b32 v76, 16, v74
    v_and_b32 v77, 0xffff0000, v74
    v_mul_f32 v78, v76, v75
    v_mul_f32 v79, v77, v75
    v_fma_f32 v76, -v78, v73, v76
    v_fma_f32 v77, -v79, v73, v77
    v_fmac_f32 v78, v76, v75
    v_fmac_f32 v79, v77, v75
    v_cvt_pk_bf16_f32 v241, v78, v79
    v_lshlrev_b32 v90, 16, v241
    v_and_b32 v91, 0xffff0000, v241
    v_sub_f32 v76, v228, v72
    v_sub_f32 v77, v229, v72
    v_cvt_pk_bf16_f32 v74, v76, v77
    v_lshlrev_b32 v76, 16, v74
    v_and_b32 v77, 0xffff0000, v74
    v_mul_f32 v78, v76, v75
    v_mul_f32 v79, v77, v75
    v_fma_f32 v76, -v78, v73, v76
    v_fma_f32 v77, -v79, v73, v77
    v_fmac_f32 v78, v76, v75
    v_fmac_f32 v79, v77, v75
    v_cvt_pk_bf16_f32 v242, v78, v79
    v_lshlrev_b32 v92, 16, v242
    v_and_b32 v93, 0xffff0000, v242
    v_sub_f32 v76, v230, v72
    v_sub_f32 v77, v231, v72
    v_cvt_pk_bf16_f32 v74, v76, v77
    v_lshlrev_b32 v76, 16, v74
    v_and_b32 v77, 0xffff0000, v74
    v_mul_f32 v78, v76, v75
    v_mul_f32 v79, v77, v75
    v_fma_f32 v76, -v78, v73, v76
    v_fma_f32 v77, -v79, v73, v77
    v_fmac_f32 v78, v76, v75
    v_fmac_f32 v79, v77, v75
    v_cvt_pk_bf16_f32 v243, v78, v79
    v_lshlrev_b32 v94, 16, v243
    v_and_b32 v95, 0xffff0000, v243
    s_mov_b64 exec, s[56:57]
    s_not_b64 exec, exec
    v_mov_b32 v88, 0
    v_mov_b32 v89, 0
    v_mov_b32 v90, 0
    v_mov_b32 v91, 0
    v_mov_b32 v92, 0
    v_mov_b32 v93, 0
    v_mov_b32 v94, 0
    v_mov_b32 v95, 0
    s_mov_b64 exec, -1
    v_add_f32 v72, v88, v89
    v_mul_f32 v73, v88, v88
    v_fmac_f32 v73, v89, v89
    v_add_f32 v72, v72, v90
    v_fmac_f32 v73, v90, v90
    v_add_f32 v72, v72, v91
    v_fmac_f32 v73, v91, v91
    v_add_f32 v72, v72, v92
    v_fmac_f32 v73, v92, v92
    v_add_f32 v72, v72, v93
    v_fmac_f32 v73, v93, v93
    v_add_f32 v72, v72, v94
    v_fmac_f32 v73, v94, v94
    v_add_f32 v72, v72, v95
    v_fmac_f32 v73, v95, v95
    s_nop 1
    v_add_f32_dpp v72, v72, v72 row_ror:8 row_mask:0xf bank_mask:0xf
    v_add_f32_dpp v73, v73, v73 row_ror:8 row_mask:0xf bank_mask:0xf
    s_nop 0
    v_add_f32_dpp v72, v72, v72 row_ror:4 row_mask:0xf bank_mask:0xf
    v_add_f32_dpp v73, v73, v73 row_ror:4 row_mask:0xf bank_mask:0xf
    s_nop 0
    v_add_f32_dpp v72, v72, v72 row_ror:2 row_mask:0xf bank_mask:0xf
    v_add_f32_dpp v73, v73, v73 row_ror:2 row_mask:0xf bank_mask:0xf
    s_nop 0
    v_add_f32_dpp v72, v72, v72 row_ror:1 row_mask:0xf bank_mask:0xf
    v_add_f32_dpp v73, v73, v73 row_ror:1 row_mask:0xf bank_mask:0xf
    s_nop 0
    v_mov_b32 v74, v72
    v_mov_b32 v75, v73
    s_nop 1
    v_permlane16_swap_b32 v72, v74
    v_permlane16_swap_b32 v73, v75
    s_nop 0
    v_add_f32 v72, v72, v74
    v_add_f32 v73, v73, v75
    v_mov_b32 v74, v72
    v_mov_b32 v75, v73
    s_nop 1
    v_permlane32_swap_b32 v72, v74
    v_permlane32_swap_b32 v73, v75
    s_nop 0
    v_add_f32 v72, v72, v74
    v_add_f32 v73, v73, v75
    v_mul_f32 v72, 0x3b124925, v72
    v_mul_f32 v73, 0x3b124925, v73
    v_fma_f32 v73, -v72, v72, v73
    v_max_f32 v73, 0, v73
    v_cvt_pk_bf16_f32 v74, v72, v73
    v_lshlrev_b32 v72, 16, v74
    v_and_b32 v73, 0xffff0000, v74
    v_add_f32 v73, 0x3727c5ac, v73
    v_cvt_pk_bf16_f32 v74, v73, v73
    v_lshlrev_b32 v73, 16, v74
    v_sqrt_f32 v73, v73
    s_nop 0
    v_cvt_pk_bf16_f32 v74, v73, v73
    v_lshlrev_b32 v73, 16, v74
    v_rcp_f32 v75, v73
    v_sub_f32 v76, v88, v72
    v_sub_f32 v77, v89, v72
    v_cvt_pk_bf16_f32 v74, v76, v77
    v_lshlrev_b32 v76, 16, v74
    v_and_b32 v77, 0xffff0000, v74
    v_mul_f32 v78, v76, v75
    v_mul_f32 v79, v77, v75
    v_fma_f32 v76, -v78, v73, v76
    v_fma_f32 v77, -v79, v73, v77
    v_fmac_f32 v78, v76, v75
    v_fmac_f32 v79, v77, v75
    v_cvt_pk_bf16_f32 v240, v78, v79
    v_sub_f32 v76, v90, v72
    v_sub_f32 v77, v91, v72
    v_cvt_pk_bf16_f32 v74, v76, v77
    v_lshlrev_b32 v76, 16, v74
    v_and_b32 v77, 0xffff0000, v74
    v_mul_f32 v78, v76, v75
    v_mul_f32 v79, v77, v75
    v_fma_f32 v76, -v78, v73, v76
    v_fma_f32 v77, -v79, v73, v77
    v_fmac_f32 v78, v76, v75
    v_fmac_f32 v79, v77, v75
    v_cvt_pk_bf16_f32 v241, v78, v79
    v_sub_f32 v76, v92, v72
    v_sub_f32 v77, v93, v72
    v_cvt_pk_bf16_f32 v74, v76, v77
    v_lshlrev_b32 v76, 16, v74
    v_and_b32 v77, 0xffff0000, v74
    v_mul_f32 v78, v76, v75
    v_mul_f32 v79, v77, v75
    v_fma_f32 v76, -v78, v73, v76
    v_fma_f32 v77, -v79, v73, v77
    v_fmac_f32 v78, v76, v75
    v_fmac_f32 v79, v77, v75
    v_cvt_pk_bf16_f32 v242, v78, v79
    v_sub_f32 v76, v94, v72
    v_sub_f32 v77, v95, v72
    v_cvt_pk_bf16_f32 v74, v76, v77
    v_lshlrev_b32 v76, 16, v74
    v_and_b32 v77, 0xffff0000, v74
    v_mul_f32 v78, v76, v75
    v_mul_f32 v79, v77, v75
    v_fma_f32 v76, -v78, v73, v76
    v_fma_f32 v77, -v79, v73, v77
    v_fmac_f32 v78, v76, v75
    v_fmac_f32 v79, v77, v75
    v_cvt_pk_bf16_f32 v243, v78, v79
    s_mov_b64 exec, s[56:57]
    ds_write_b128 v252, v[240:243]
    s_mov_b64 exec, -1
    s_waitcnt lgkmcnt(0)
    ds_read_b128 v[72:75], v253 offset:0
    ds_read_b128 v[76:79], v253 offset:64
    ds_read_b128 v[80:83], v253 offset:128
    ds_read_b128 v[84:87], v253 offset:192
    ds_read_b128 v[88:91], v253 offset:256
    ds_read_b128 v[92:95], v253 offset:320
    ds_read_b128 v[96:99], v253 offset:384
    ds_read_b128 v[100:103], v253 offset:448
    ds_read_b128 v[104:107], v253 offset:512
    ds_read_b128 v[108:111], v253 offset:576
    ds_read_b128 v[112:115], v253 offset:640
    ds_read_b128 v[116:119], v253 offset:704
    ds_read_b128 v[120:123], v253 offset:768
    ds_read_b128 v[124:127], v253 offset:832
    s_waitcnt lgkmcnt(12)
    v_mfma_f32_16x16x32_bf16 v[244:247], v[72:75], v[16:19], 0
    v_mfma_f32_16x16x32_bf16 v[244:247], v[76:79], v[20:23], v[244:247]
    s_waitcnt lgkmcnt(10)
    v_mfma_f32_16x16x32_bf16 v[244:247], v[80:83], v[24:27], v[244:247]
    v_mfma_f32_16x16x32_bf16 v[244:247], v[84:87], v[28:31], v[244:247]
    s_waitcnt lgkmcnt(8)
    v_mfma_f32_16x16x32_bf16 v[244:247], v[88:91], v[32:35], v[244:247]
    v_mfma_f32_16x16x32_bf16 v[244:247], v[92:95], v[36:39], v[244:247]
    s_waitcnt lgkmcnt(6)
    v_mfma_f32_16x16x32_bf16 v[244:247], v[96:99], v[40:43], v[244:247]
    v_mfma_f32_16x16x32_bf16 v[244:247], v[100:103], v[44:47], v[244:247]
    s_waitcnt lgkmcnt(4)
    v_mfma_f32_16x16x32_bf16 v[244:247], v[104:107], v[48:51], v[244:247]
    v_mfma_f32_16x16x32_bf16 v[244:247], v[108:111], v[52:55], v[244:247]
    s_waitcnt lgkmcnt(2)
    v_mfma_f32_16x16x32_bf16 v[244:247], v[112:115], v[56:59], v[244:247]
    v_mfma_f32_16x16x32_bf16 v[244:247], v[116:119], v[60:63], v[244:247]
    s_waitcnt lgkmcnt(0)
    v_mfma_f32_16x16x32_bf16 v[244:247], v[120:123], v[64:67], v[244:247]
    v_mfma_f32_16x16x32_bf16 v[244:247], v[124:127], v[68:71], v[244:247]
    s_nop 8
    v_cvt_pk_bf16_f32 v244, v244, v244
    v_lshlrev_b32 v244, 16, v244
    v_add_f32 v244, v244, v255
    v_cvt_pk_bf16_f32 v244, v244, v244
    v_lshlrev_b32 v244, 16, v244
    v_mul_f32 v245, v244, v244
    v_mul_f32 v245, v245, v244
    v_mov_b32 v246, v244
    v_fmac_f32 v246, 0x3d372713, v245
    v_mul_f32 v246, 0x40135761, v246
    v_exp_f32 v246, v246
    s_nop 0
    v_add_f32 v246, 1.0, v246
    v_rcp_f32 v246, v246
    s_nop 0
    v_sub_f32 v246, 1.0, v246
    v_mul_f32 v244, v244, v246
    v_cvt_pk_bf16_f32 v244, v244, v244
    s_nop 0
    v_readlane_b32 s77, v244, 0
    v_readlane_b32 s78, v244, 1
    s_nop 0
    s_pack_ll_b32_b16 s48, s77, s78
    v_readlane_b32 s77, v244, 2
    v_readlane_b32 s78, v244, 3
    s_nop 0
    s_pack_ll_b32_b16 s49, s77, s78
    v_readlane_b32 s77, v244, 4
    v_readlane_b32 s78, v244, 5
    s_nop 0
    s_pack_ll_b32_b16 s50, s77, s78
    v_readlane_b32 s77, v244, 6
    v_readlane_b32 s78, v244, 7
    s_nop 0
    s_pack_ll_b32_b16 s51, s77, s78
    s_nop 1
    v_dot2_f32_bf16 v96, s48, v192, 0
    v_dot2_f32_bf16 v97, s48, v196, 0
    v_dot2_f32_bf16 v98, s48, v193, 0
    v_dot2_f32_bf16 v99, s48, v197, 0
    v_dot2_f32_bf16 v100, s48, v194, 0
    v_dot2_f32_bf16 v101, s48, v198, 0
    v_dot2_f32_bf16 v102, s48, v195, 0
    v_dot2_f32_bf16 v103, s48, v199, 0
    v_dot2_f32_bf16 v96, s49, v200, v96
    v_dot2_f32_bf16 v97, s49, v204, v97
    v_dot2_f32_bf16 v98, s49, v201, v98
    v_dot2_f32_bf16 v99, s49, v205, v99
    v_dot2_f32_bf16 v100, s49, v202, v100
    v_dot2_f32_bf16 v101, s49, v206, v101
    v_dot2_f32_bf16 v102, s49, v203, v102
    v_dot2_f32_bf16 v103, s49, v207, v103
    v_dot2_f32_bf16 v96, s50, v208, v96
    v_dot2_f32_bf16 v97, s50, v212, v97
    v_dot2_f32_bf16 v98, s50, v209, v98
    v_dot2_f32_bf16 v99, s50, v213, v99
    v_dot2_f32_bf16 v100, s50, v210, v100
    v_dot2_f32_bf16 v101, s50, v214, v101
    v_dot2_f32_bf16 v102, s50, v211, v102
    v_dot2_f32_bf16 v103, s50, v215, v103
    v_dot2_f32_bf16 v96, s51, v216, v96
    v_dot2_f32_bf16 v97, s51, v220, v97
    v_dot2_f32_bf16 v98, s51, v217, v98
    v_dot2_f32_bf16 v99, s51, v221, v99
    v_dot2_f32_bf16 v100, s51, v218, v100
    v_dot2_f32_bf16 v101, s51, v222, v101
    v_dot2_f32_bf16 v102, s51, v219, v102
    v_dot2_f32_bf16 v103, s51, v223, v103
    s_nop 2
    v_bfi_b32 v96, 3, s33, v96
    v_bfi_b32 v100, 3, s33, v100
    s_lshl_b32 s40, s30, 16
    s_lshl_b32 s41, s31, 6
    s_add_u32 s40, s40, s41
    s_add_u32 s40, s40, 3145728
    v_lshrrev_b32 v15, 1, v0
    v_lshlrev_b32 v15, 11, v15
    v_and_b32 v248, 1, v0
    v_lshlrev_b32 v248, 5, v248
    v_add3_u32 v15, v15, v248, s40
    s_mov_b64 exec, s[56:57]
    s_cmp_eq_u32 s34, 1
    s_cbranch_scc1 L_f_47
    global_store_dwordx4 v15, v[96:99], s[28:29] sc1
    global_store_dwordx4 v15, v[100:103], s[28:29] offset:16 sc1
    s_branch L_e_48
L_f_47:
    global_store_dwordx4 v15, v[96:99], s[28:29]
    global_store_dwordx4 v15, v[100:103], s[28:29] offset:16
L_e_48:
    s_mov_b64 exec, -1
    v_mov_b32 v76, s33
    v_mov_b32 v77, 0
    v_mov_b32 v78, 0
    v_mov_b32 v79, 0
    s_mov_b32 s35, 0
L_poll_49:
    global_load_dwordx4 v[72:75], v8, s[28:29] sc1
    s_mov_b32 exec_hi, 0xffff
    global_load_dwordx4 v[76:79], v8, s[28:29] offset:1024 sc1
    s_mov_b64 exec, -1
    s_add_u32 s35, s35, 1
    s_cmp_gt_u32 s35, 400000
    s_cbranch_scc1 L_abort
    s_waitcnt vmcnt(0)
    v_and_b32 v248, s33, v72
    v_and_b32 v248, v248, v76
    v_cmp_ne_u32 vcc, 0, v248
    s_nop 1
    s_cmp_eq_u64 vcc, exec
    s_cbranch_scc0 L_poll_49
    v_add_f32 v72, v72, v76
    v_add_f32 v73, v73, v77
    v_add_f32 v74, v74, v78
    v_add_f32 v75, v75, v79
    s_nop 1
    v_add_f32_dpp v72, v72, v72 row_ror:4 row_mask:0xf bank_mask:0xf
    v_add_f32_dpp v73, v73, v73 row_ror:4 row_mask:0xf bank_mask:0xf
    v_add_f32_dpp v74, v74, v74 row_ror:4 row_mask:0xf bank_mask:0xf
    v_add_f32_dpp v75, v75, v75 row_ror:4 row_mask:0xf bank_mask:0xf
    v_add_f32_dpp v72, v72, v72 row_ror:8 row_mask:0xf bank_mask:0xf
    v_add_f32_dpp v73, v73, v73 row_ror:8 row_mask:0xf bank_mask:0xf
    v_add_f32_dpp v74, v74, v74 row_ror:8 row_mask:0xf bank_mask:0xf
    v_add_f32_dpp v75, v75, v75 row_ror:8 row_mask:0xf bank_mask:0xf
    v_mov_b32 v80, v72
    v_mov_b32 v81, v73
    v_mov_b32 v82, v74
    v_mov_b32 v83, v75
    s_nop 1
    v_permlane16_swap_b32 v72, v80
    v_permlane16_swap_b32 v73, v81
    v_permlane16_swap_b32 v74, v82
    v_permlane16_swap_b32 v75, v83
    s_nop 0
    v_add_f32 v72, v72, v80
    v_add_f32 v73, v73, v81
    v_add_f32 v74, v74, v82
    v_add_f32 v75, v75, v83
    v_mov_b32 v80, v72
    v_mov_b32 v81, v73
    v_mov_b32 v82, v74
    v_mov_b32 v83, v75
    s_nop 1
    v_permlane32_swap_b32 v72, v80
    v_permlane32_swap_b32 v73, v81
    v_permlane32_swap_b32 v74, v82
    v_permlane32_swap_b32 v75, v83
    s_nop 0
    v_add_f32 v72, v72, v80
    v_add_f32 v73, v73, v81
    v_add_f32 v74, v74, v82
    v_add_f32 v75, v75, v83
    v_bfi_b32 v72, 3, s33, v72
    s_mov_b64 exec, s[58:59]
    global_store_dwordx4 v13, v[72:75], s[28:29] sc1
    s_mov_b64 exec, -1
    s_lshl_b32 s40, s31, 9
    s_add_u32 s40, s40, 262144
    v_add_u32 v15, s40, v5
    v_mov_b32 v76, 0
    v_mov_b32 v77, 0
    v_mov_b32 v78, 0
    v_mov_b32 v79, 0
    s_mov_b64 exec, s[60:61]
    s_mov_b32 s35, 0
    global_load_dwordx4 v[112:115], v15, s[28:29] sc1
    global_load_dwordx4 v[116:119], v15, s[28:29] sc1
L_xs_50:
    s_add_u32 s35, s35, 1
    s_cmp_gt_u32 s35, 400000
    s_cbranch_scc1 L_abort
    s_waitcnt vmcnt(1)
    v_and_b32 v248, s33, v112
    v_cmp_ne_u32 vcc, 0, v248
    s_nop 1
    s_cmp_eq_u64 vcc, exec
    s_cbranch_scc1 L_xsd_52
    global_load_dwordx4 v[112:115], v15, s[28:29] sc1
    s_waitcnt vmcnt(1)
    v_and_b32 v248, s33, v116
    v_cmp_ne_u32 vcc, 0, v248
    s_nop 1
    s_cmp_eq_u64 vcc, exec
    s_cbranch_scc1 L_xsd_53
    global_load_dwordx4 v[116:119], v15, s[28:29] sc1
    s_branch L_xs_50
L_xsd_52:
    v_mov_b32 v76, v112
    v_mov_b32 v77, v113
    v_mov_b32 v78, v114
    v_mov_b32 v79, v115
    s_branch L_xse_51
L_xsd_53:
    v_mov_b32 v76, v116
    v_mov_b32 v77, v117
    v_mov_b32 v78, v118
    v_mov_b32 v79, v119
    s_branch L_xse_51
L_xse_51:
    s_mov_b64 exec, -1
    s_nop 1
    v_add_f32_dpp v76, v76, v76 row_ror:4 row_mask:0xf bank_mask:0xf
    v_add_f32_dpp v77, v77, v77 row_ror:4 row_mask:0xf bank_mask:0xf
    v_add_f32_dpp v78, v78, v78 row_ror:4 row_mask:0xf bank_mask:0xf
    v_add_f32_dpp v79, v79, v79 row_ror:4 row_mask:0xf bank_mask:0xf
    v_add_f32_dpp v76, v76, v76 row_ror:8 row_mask:0xf bank_mask:0xf
    v_add_f32_dpp v77, v77, v77 row_ror:8 row_mask:0xf bank_mask:0xf
    v_add_f32_dpp v78, v78, v78 row_ror:8 row_mask:0xf bank_mask:0xf
    v_add_f32_dpp v79, v79, v79 row_ror:8 row_mask:0xf bank_mask:0xf
    v_mov_b32 v80, v76
    v_mov_b32 v81, v77
    v_mov_b32 v82, v78
    v_mov_b32 v83, v79
    s_nop 1
    v_permlane16_swap_b32 v76, v80
    v_permlane16_swap_b32 v77, v81
    v_permlane16_swap_b32 v78, v82
    v_permlane16_swap_b32 v79, v83
    s_nop 0
    v_add_f32 v76, v76, v80
    v_add_f32 v77, v77, v81
    v_add_f32 v78, v78, v82
    v_add_f32 v79, v79, v83
    v_cvt_pk_bf16_f32 v248, v76, v77
    v_lshlrev_b32 v76, 16, v248
    v_and_b32 v77, 0xffff0000, v248
    v_cvt_pk_bf16_f32 v248, v78, v79
    v_lshlrev_b32 v78, 16, v248
    v_and_b32 v79, 0xffff0000, v248
    v_add_f32 v76, v76, v236
    v_add_f32 v77, v77, v237
    v_add_f32 v78, v78, v238
    v_add_f32 v79, v79, v239
    v_cvt_pk_bf16_f32 v248, v76, v77
    v_lshlrev_b32 v76, 16, v248
    v_and_b32 v77, 0xffff0000, v248
    v_cvt_pk_bf16_f32 v248, v78, v79
    v_lshlrev_b32 v78, 16, v248
    v_and_b32 v79, 0xffff0000, v248
    v_add_f32 v232, v232, v76
    v_add_f32 v233, v233, v77
    v_add_f32 v234, v234, v78
    v_add_f32 v235, v235, v79
    v_cvt_pk_bf16_f32 v248, v232, v233
    v_lshlrev_b32 v232, 16, v248
    v_and_b32 v233, 0xffff0000, v248
    v_cvt_pk_bf16_f32 v248, v234, v235
    v_lshlrev_b32 v234, 16, v248
    v_and_b32 v235, 0xffff0000, v248
    s_cmp_lg_u32 s76, 0
    s_cbranch_scc1 L_ctrl_final
    v_or_b32 v76, s33, v232
    v_mov_b32 v77, v233
    v_mov_b32 v78, v234
    v_mov_b32 v79, v235
    s_mov_b64 exec, s[58:59]
    s_cmp_eq_u32 s34, 1
    s_cbranch_scc1 L_f_54
    global_store_dwordx4 v11, v[76:79], s[28:29] sc1
    s_branch L_e_55
L_f_54:
    global_store_dwordx4 v11, v[76:79], s[28:29]
L_e_55:
    s_mov_b64 exec, -1
L_ctrl_skipmlp:
    s_cmp_lg_u32 s76, 0
    s_cbranch_scc1 L_ctrl_done
    ds_read_b64_tr_b16 v[16:17], v250 offset:0
    ds_read_b64_tr_b16 v[18:19], v250 offset:128
    ds_read_b64_tr_b16 v[20:21], v250 offset:1024
    ds_read_b64_tr_b16 v[22:23], v250 offset:1152
    ds_read_b64_tr_b16 v[24:25], v250 offset:2048
    ds_read_b64_tr_b16 v[26:27], v250 offset:2176
    ds_read_b64_tr_b16 v[28:29], v250 offset:3072
    ds_read_b64_tr_b16 v[30:31], v250 offset:3200
    ds_read_b64_tr_b16 v[32:33], v250 offset:4096
    ds_read_b64_tr_b16 v[34:35], v250 offset:4224
    ds_read_b64_tr_b16 v[36:37], v250 offset:5120
    ds_read_b64_tr_b16 v[38:39], v250 offset:5248
    ds_read_b64_tr_b16 v[40:41], v250 offset:6144
    ds_read_b64_tr_b16 v[42:43], v250 offset:6272
    ds_read_b64_tr_b16 v[44:45], v250 offset:7168
    ds_read_b64_tr_b16 v[46:47], v250 offset:7296
    ds_read_b64_tr_b16 v[48:49], v250 offset:8192
    ds_read_b64_tr_b16 v[50:51], v250 offset:8320
    ds_read_b64_tr_b16 v[52:53], v250 offset:9216
    ds_read_b64_tr_b16 v[54:55], v250 offset:9344
    ds_read_b64_tr_b16 v[56:57], v250 offset:10240
    ds_read_b64_tr_b16 v[58:59], v250 offset:10368
    ds_read_b64_tr_b16 v[60:61], v250 offset:11264
    ds_read_b64_tr_b16 v[62:63], v250 offset:11392
    ds_read_b64_tr_b16 v[64:65], v250 offset:12288
    ds_read_b64_tr_b16 v[66:67], v250 offset:12416
    ds_read_b64_tr_b16 v[68:69], v250 offset:13312
    ds_read_b64_tr_b16 v[70:71], v250 offset:13440
    s_lshl_b32 s40, s30, 11
    s_add_u32 s40, s40, 131072
    v_lshlrev_b32 v15, 5, v0
    v_add_u32 v15, s40, v15
    s_mov_b64 exec, s[56:57]
    s_mov_b32 s35, 0
L_poll_56:
    global_load_dwordx4 v[224:227], v15, s[28:29] sc1
    global_load_dwordx4 v[228:231], v15, s[28:29] offset:16 sc1
    s_add_u32 s35, s35, 1
    s_cmp_gt_u32 s35, 400000
    s_cbranch_scc1 L_abort
    s_waitcnt vmcnt(0)
    v_and_b32 v248, s33, v224
    v_and_b32 v248, v248, v228
    v_cmp_ne_u32 vcc, 0, v248
    s_nop 1
    s_cmp_eq_u64 vcc, exec
    s_cbranch_scc0 L_poll_56
    v_and_b32 v224, 0xffff0000, v224
    v_and_b32 v228, 0xffff0000, v228
    s_mov_b64 exec, -1
    s_mov_b32 s76, 1
    s_mov_b32 s33, 2
    s_branch L_ctrl_layer
L_ctrl_final:
    s_cmp_lg_u32 s30, 0
    s_cbranch_scc1 L_ctrl_done
    v_cvt_pk_bf16_f32 v240, v232, v233
    v_cvt_pk_bf16_f32 v241, v234, v235
    s_mov_b64 exec, s[58:59]
    global_store_dwordx2 v14, v[240:241], s[24:25]
    s_mov_b64 exec, -1
L_ctrl_done:
L_abort:
L_end:
    s_endpgm
.section .rodata,"a"
.p2align 6
.amdhsa_kernel interleave_layers__sliding_block_cached__mixer_channel_mlp__decode_kernel
  .amdhsa_next_free_vgpr 256
  .amdhsa_next_free_sgpr 102
  .amdhsa_accum_offset 256
  .amdhsa_group_segment_fixed_size 0
  .amdhsa_kernarg_size 104
  .amdhsa_user_sgpr_count 2
  .amdhsa_user_sgpr_kernarg_segment_ptr 1
  .amdhsa_system_sgpr_workgroup_id_x 1
.end_amdhsa_kernel
```
